```python
import torch

def _softmax(x, axis=-1):
    return torch.softmax(x, dim=axis)
def _gelu(x):
    return torch.nn.functional.gelu(x, approximate="tanh")
def _silu(x):
    return torch.nn.functional.silu(x)
def _sigmoid(x):
    return torch.sigmoid(x)
def _layernorm(x, axis=-1, eps=1e-5):
    m = x.mean(dim=axis, keepdim=True)
    v = x.var(dim=axis, keepdim=True, unbiased=False)
    return (x - m) / torch.sqrt(v + eps)
def _scatter_add(tgt, idx, src, axis=0):
    return tgt.clone().index_add_(axis, idx, src)
def _segment_sum(src, seg, n):
    out = torch.zeros((n,) + src.shape[1:], dtype=src.dtype)
    return out.index_add_(0, seg, src)
def _pad(x, pw):
    flat = tuple(v for pair in reversed(pw) for v in pair)
    return torch.nn.functional.pad(x, flat)

kernel_name = 'gated_mix__sliding_local_dilated__dense_activation_relu__prompt'

def setup_inputs():

    _w = (lambda a: (lambda t: t.to(torch.bfloat16) if t.is_floating_point() else t)(torch.as_tensor(a)))
    def _A_setup():
        B, S, D = 1, 2048, 512
        return {
            "x": _w((lambda *s: torch.randn(*s, dtype=torch.bfloat16) * 0.05)(B, S, D)),
            "wqkv": _w((lambda *s: torch.randn(*s, dtype=torch.bfloat16) * 1.6)(D, 3 * D)),
            "wo": _w((lambda *s: torch.randn(*s, dtype=torch.bfloat16) * 0.05)(D, D)),
        }
    _A_in = _A_setup()

    def _B_setup():
        B, S, D, Dff = 1, 2048, 512, 1792
        return {
            "x": _w((lambda *s: torch.randn(*s, dtype=torch.bfloat16) * 0.05)(B, S, D)),
            "w1": _w((lambda *s: torch.randn(*s, dtype=torch.bfloat16) * 0.2)(D, Dff)),
            "w2": _w((lambda *s: torch.randn(*s, dtype=torch.bfloat16) * 0.2)(Dff, D)),
        }
    _B_in = _B_setup()

    return {
        "A_x": _A_in["x"],
        "A_wqkv": _A_in["wqkv"],
        "A_wo": _A_in["wo"],
        "B_x": _B_in["x"],
        "B_w1": _B_in["w1"],
        "B_w2": _B_in["w2"],
        "gate_w": _w((lambda *s: torch.randn(*s, dtype=torch.bfloat16) * 0.05)(512) * 16.0),
    }

def reference(A_x, A_wqkv, A_wo, B_x, B_w1, B_w2, gate_w):
    def _A_ref(x, wqkv, wo):
        B, S, D = x.shape
        H = 32; Dh = D // H
        W, dil = 8, 2
        qkv = (lambda x, *d: x.permute(*d))((x @ wqkv).reshape(B, S, 3, H, Dh), 2, 0, 3, 1, 4)
        q, k, v = qkv[0], qkv[1], qkv[2]
        scale = Dh ** -0.5
        pos = torch.arange(S)
        off = torch.arange(W) * dil
        idx = pos[:, None] - off[None, :]
        mask = idx >= 0
        idx_c = torch.where(mask, idx, 0).reshape(-1)
        kg = k[:, :, idx_c, :].reshape(B, H, S, W, Dh)
        vg = v[:, :, idx_c, :].reshape(B, H, S, W, Dh)
        logits = torch.einsum("bhsd,bhswd->bhsw", q, kg) * scale
        logits = torch.where(mask[None, None, :, :], logits, -1e9)
        attn = _softmax(logits, axis=-1)
        o = torch.einsum("bhsw,bhswd->bhsd", attn, vg)
        return (lambda x, *d: x.permute(*d))(o, 0, 2, 1, 3).reshape(B, S, D) @ wo

    def _B_ref(x, w1, w2):
        h = torch.einsum("bsd,df->bsf", x, w1)
        zero = torch.zeros_like(h)
        h = torch.maximum(h, zero)
        return torch.einsum("bsf,fd->bsd", h, w2)

    x = A_x
    g = _sigmoid((x * gate_w).sum(-1, keepdims=True))
    a = _A_ref(x, A_wqkv, A_wo)
    b = _B_ref(x, B_w1, B_w2)
    return g * a + (1 - g) * b
```

```asm
; @launch grid=(256,1,1) block=(512,1,1) lds=163840
.amdgcn_target "amdgcn-amd-amdhsa--gfx950"
.text
.globl gated_mix__sliding_local_dilated__dense_activation_relu__prompt_kernel
.p2align 8
.type gated_mix__sliding_local_dilated__dense_activation_relu__prompt_kernel,@function
gated_mix__sliding_local_dilated__dense_activation_relu__prompt_kernel:
s_cmp_ge_u32 s2, 256
s_cbranch_scc1 K_END
s_load_dwordx16 s[4:19], s[0:1], 0
s_load_dwordx4 s[20:23], s[0:1], 64
v_lshrrev_b32 v1, 6, v0
v_and_b32 v0, 63, v0
v_readfirstlane_b32 s3, v1
s_and_b32 s64, s2, 4
s_lshr_b32 s65, s2, 3
s_lshl_b32 s64, s64, 1
s_and_b32 s65, s65, 7
s_add_u32 s24, s64, s65
s_and_b32 s27, s3, 3
s_xor_b32 s3, s3, 4
s_cmp_lt_u32 s3, 4
s_cbranch_scc1 K_HOP
s_cmp_ge_u32 s2, 8
s_cbranch_scc1 CS_1
s_getpc_b64 s[64:65]
GP_2:
s_lshl_b32 s66, s27, 13
v_lshlrev_b32 v10, 7, v0
v_add_u32 v10, s66, v10
s_mov_b32 s66, K_CODE_END-GP_2-4
v_min_u32 v10, s66, v10
global_load_dword v255, v10, s[64:65]
CS_1:
v_lshrrev_b32 v10, 3, v0
v_and_b32 v11, 7, v0
v_lshrrev_b32 v12, 4, v0
s_and_b32 s68, s27, 1
s_lshr_b32 s69, s27, 1
s_lshl_b32 s64, s24, 1
s_add_u32 s64, s64, s68
s_lshl_b32 s64, s64, 6
s_add_u32 s64, s64, s69
s_lshl_b32 s64, s64, 10
v_xor_b32 v13, v11, v12
v_lshlrev_b32 v14, 11, v10
v_lshl_add_u32 v14, v13, 4, v14
v_add_u32 v2, s64, v14
v_xor_b32 v3, 64, v2
s_mov_b32 s35, 0x20000
s_lshl_b32 s34, s35, 4
s_lshl_b32 s70, s27, 12
s_add_u32 m0, s70, 45056
s_movk_i32 s51, 0x4000
s_waitcnt lgkmcnt(0)
s_mov_b64 s[32:33], s[4:5]
buffer_load_dwordx4 v2, s[32:35], 0 offen lds
s_addk_i32 m0, 0x400
s_nop 0
buffer_load_dwordx4 v3, s[32:35], s51 offen lds
s_addk_i32 m0, 0x400
s_addk_i32 s51, 0x4000
buffer_load_dwordx4 v2, s[32:35], s51 offen lds
s_addk_i32 m0, 0x400
s_addk_i32 s51, 0x4000
buffer_load_dwordx4 v3, s[32:35], s51 offen lds
s_branch K_HOPS
K_HOP:
s_branch K_CPRE
K_HOPS:
s_and_b32 s64, s2, 7
s_lshr_b32 s65, s2, 3
s_lshr_b32 s66, s65, 3
s_and_b32 s25, s66, 1
s_and_b32 s67, s64, 3
s_lshl_b32 s26, s67, 1
s_lshr_b32 s67, s66, 1
s_add_u32 s26, s26, s67
s_movk_i32 s74, 3584
s_movk_i32 s75, 128
s_movk_i32 s66, 448
s_mul_i32 s66, s66, s26
s_and_b32 s67, s26, 1
s_lshl_b32 s64, s67, 6
s_add_u32 s64, s64, s66
s_lshl_b32 s65, s26, 7
s_cmp_eq_u32 s25, 0
s_cmovk_i32 s74, 3072
s_cmovk_i32 s75, 1024
s_cselect_b32 s64, s65, s64
s_lshl_b32 s38, s74, 9
s_mov_b32 s39, s35
s_mov_b32 s43, s35
v_and_b32 v15, 1, v12
s_lshl_b32 s65, s68, 2
v_xor_b32 v13, s65, v11
v_lshlrev_b32 v15, 1, v15
v_xor_b32 v15, v15, v13
s_lshl_b32 s65, s27, 3
v_add_u32 v4, s65, v10
v_mul_u32_u24 v4, s74, v4
v_lshl_add_u32 v4, v15, 4, v4
v_add_u32 v4, s64, v4
s_lshl_b32 s71, s27, 10
s_addk_i32 s71, 16384
s_lshl_b32 s73, s74, 6
s_lshl_b32 s74, s74, 5
s_cmp_eq_u32 s25, 0
s_cselect_b64 s[36:37], s[6:7], s[12:13]
s_cselect_b64 s[40:41], s[4:5], s[12:13]
s_add_u32 m0, s71, 45056
s_mov_b32 s50, 0
buffer_load_dwordx4 v4, s[36:39], s50 offen lds
s_addk_i32 m0, 0x2000
s_add_u32 s50, s50, s75
buffer_load_dwordx4 v4, s[36:39], s50 offen lds
s_addk_i32 m0, 0x2000
s_add_u32 s50, s50, s75
buffer_load_dwordx4 v4, s[36:39], s50 offen lds
s_addk_i32 m0, 0x1000
s_add_u32 s50, s50, s74
buffer_load_dwordx4 v4, s[36:39], s50 offen lds
s_addk_i32 m0, -0x2000
s_sub_u32 s50, s50, s75
buffer_load_dwordx4 v4, s[36:39], s50 offen lds
s_addk_i32 m0, -0x2000
s_sub_u32 s50, s50, s75
buffer_load_dwordx4 v4, s[36:39], s50 offen lds
s_cmp_eq_u32 s25, 0
s_cbranch_scc1 KL_EA
s_cmp_eq_u32 s67, 0
s_movk_i32 s65, 0
s_cmovk_i32 s65, 384
s_add_u32 s66, s66, s65
v_lshrrev_b32 v15, 2, v0
s_lshl_b32 s65, s27, 4
v_add_u32 v15, s65, v15
v_mul_u32_u24 v5, 3584, v15
v_lshrrev_b32 v15, 5, v0
v_lshlrev_b32 v15, 1, v15
v_and_b32 v13, 3, v0
v_xor_b32 v15, v15, v13
v_lshl_add_u32 v5, v15, 4, v5
v_add_u32 v5, s66, v5
s_lshl_b32 s72, s27, 10
s_mov_b32 s76, s73
s_mov_b32 s42, s38
s_branch KL_ED
KL_EA:
s_lshl_b32 s64, s24, 7
s_cmp_eq_u32 s24, 0
s_cselect_b32 s65, -1, 15
s_cselect_b32 s42, 0, s34
s_sub_u32 s64, s64, s65
s_sub_u32 s64, s64, s68
s_lshl_b32 s64, s64, 10
s_lshl_b32 s65, s68, 6
v_xor_b32 v5, s65, v14
v_add_u32 v5, s64, v5
s_lshl_b32 s72, s68, 10
s_movk_i32 s76, 128
KL_ED:
s_add_u32 s72, s72, 40960
s_add_u32 m0, s72, 45056
s_mov_b32 s77, 1
buffer_load_dwordx4 v5, s[40:43], 0 offen lds
s_add_u32 m0, s71, 0
s_mul_i32 s50, s77, s73
buffer_load_dwordx4 v4, s[36:39], s50 offen lds
s_addk_i32 m0, 0x2000
s_add_u32 s50, s50, s75
buffer_load_dwordx4 v4, s[36:39], s50 offen lds
s_addk_i32 m0, 0x2000
s_add_u32 s50, s50, s75
buffer_load_dwordx4 v4, s[36:39], s50 offen lds
s_addk_i32 m0, 0x1000
s_add_u32 s50, s50, s74
buffer_load_dwordx4 v4, s[36:39], s50 offen lds
s_addk_i32 m0, -0x2000
s_sub_u32 s50, s50, s75
buffer_load_dwordx4 v4, s[36:39], s50 offen lds
s_addk_i32 m0, -0x2000
s_sub_u32 s50, s50, s75
buffer_load_dwordx4 v4, s[36:39], s50 offen lds
s_add_u32 m0, s72, 0
s_mul_i32 s50, s77, s76
buffer_load_dwordx4 v5, s[40:43], s50 offen lds
s_branch K_CPRE_S
K_CPRE:
s_and_b32 s64, s2, 7
s_lshr_b32 s65, s2, 3
s_lshr_b32 s66, s65, 3
s_and_b32 s25, s66, 1
s_and_b32 s67, s64, 3
s_lshl_b32 s26, s67, 1
s_lshr_b32 s67, s66, 1
s_add_u32 s26, s26, s67
s_waitcnt lgkmcnt(0)
v_lshlrev_b32 v254, 7, v0
s_mov_b32 s51, 0x20000
s_cmp_ge_u32 s2, 156
s_cbranch_scc1 DU_3
s_lshl_b32 s64, s2, 1
s_and_b32 s65, s27, 1
s_add_u32 s64, s64, s65
s_mul_i32 s65, s64, 1261
s_lshr_b32 s65, s65, 16
s_mul_i32 s66, s65, 52
s_sub_u32 s64, s64, s66
s_max_u32 s101, s65, 1
s_sub_u32 s101, s101, 1
s_add_u32 s65, s65, 2
s_cmp_lt_u32 s27, 2
s_cbranch_scc1 DU_6
s_mov_b32 s48, s4
s_mov_b32 s49, s5
s_mov_b32 s50, 2097152
v_lshlrev_b32 v254, 10, v0
s_lshl_b32 s100, s64, 16
s_lshl_b32 s65, s65, 7
s_add_u32 s100, s100, s65
s_cmp_ge_u32 s64, 32
s_cselect_b32 s101, 255, s101
s_branch DU_4
DU_6:
s_cmp_lt_u32 s64, 24
s_cselect_b32 s48, s6, s12
s_cselect_b32 s49, s7, s13
s_mov_b32 s50, 1835008
s_cselect_b32 s50, 1572864, s50
s_cselect_b32 s66, 24, 28
s_cselect_b32 s67, 0, 24
s_mul_i32 s65, s65, s66
s_add_u32 s64, s64, s65
s_sub_u32 s64, s64, s67
s_lshl_b32 s100, s64, 13
s_cmp_ge_u32 s27, 2
s_cselect_b32 s101, 255, s101
s_branch DU_4
DU_3:
s_sub_u32 s64, s2, 156
DU_3X:
s_mul_i32 s64, s64, 3
s_add_u32 s64, s64, s27
s_mul_i32 s101, s64, 911
s_lshr_b32 s101, s101, 17
s_add_u32 s101, s101, 0
s_cmp_ge_u32 s27, 3
s_cselect_b32 s101, 255, s101
s_cmp_ge_u32 s64, 288
s_cselect_b32 s101, 255, s101
s_cmp_lt_u32 s64, 64
s_cselect_b32 s48, s8, s14
s_cselect_b32 s49, s9, s15
s_mov_b32 s50, 1835008
s_cselect_b32 s50, 524288, s50
s_cselect_b32 s67, 0, 64
s_sub_u32 s64, s64, s67
s_lshl_b32 s100, s64, 13
DU_4:
s_cmp_lg_u32 s101, 0
s_cbranch_scc1 DU_5
buffer_load_dword v255, v254, s[48:51], s100 offen
DU_5:
s_branch K_COMPUTE
K_CPRE_S:
s_and_b32 s64, s2, 1
s_lshl_b32 s28, s24, 1
s_add_u32 s28, s28, s64
s_and_b32 s64, s2, 2
s_lshl_b32 s64, s64, 1
s_lshr_b32 s65, s2, 6
s_add_u32 s65, s65, s24
s_and_b32 s65, s65, 3
s_add_u32 s29, s64, s65
v_lshlrev_b32 v1, 4, v0
v_mov_b32 v7, 0
s_mov_b32 s44, s22
s_mov_b32 s45, s23
s_mov_b32 s46, 14155776
s_mov_b32 s47, 0x20000
v_and_b32 v15, 1, v12
v_lshlrev_b32 v15, 2, v15
v_xor_b32 v15, v15, v11
v_lshlrev_b32 v15, 4, v15
v_lshlrev_b32 v6, 10, v10
v_add_u32 v6, v6, v15
s_mul_i32 s100, s27, 19
s_sub_u32 s100, s100, 3
s_cmp_eq_u32 s27, 0
s_cselect_b32 s100, 0, s100
s_cselect_b32 s101, 16, 19
s_cmp_eq_u32 s27, 3
s_cselect_b32 s101, 18, s101
s_lshl_b32 s101, s101, 12
s_mul_i32 s64, s28, 72
s_add_u32 s64, s64, s100
s_lshl_b32 s64, s64, 12
s_add_u32 s56, s22, s64
s_addc_u32 s57, s23, 0
s_mov_b32 s58, s101
s_mov_b32 s59, 0x20000
s_sub_u32 s64, s100, 16
s_lshl_b32 s64, s64, 15
s_cmp_eq_u32 s27, 0
s_cselect_b32 s64, 0, s64
s_cselect_b32 s66, s8, s14
s_cselect_b32 s67, s9, s15
s_lshl_b32 s65, s29, 7
s_add_u32 s64, s64, s65
s_add_u32 s60, s66, s64
s_addc_u32 s61, s67, 0
s_lshl_b32 s62, s101, 3
s_sub_u32 s62, s62, s65
s_mov_b32 s63, 0x20000
s_lshl_b32 s79, s27, 12
s_sub_u32 s79, 159744, s79
s_cmp_eq_u32 s27, 0
s_cselect_b32 s79, 143360, s79
v_mov_b32 v13, 159744
ds_write_b32 v13, v7
s_waitcnt lgkmcnt(0)
v_lshrrev_b32 v13, 5, v0
v_lshlrev_b32 v13, 10, v13
v_bfe_u32 v14, v0, 2, 2
v_lshlrev_b32 v14, 7, v14
v_add_u32 v13, v13, v14
v_bfe_u32 v14, v0, 3, 1
v_lshlrev_b32 v14, 6, v14
v_add_u32 v13, v13, v14
v_bfe_u32 v14, v0, 4, 1
v_lshlrev_b32 v14, 5, v14
v_add_u32 v13, v13, v14
v_and_b32 v14, 3, v0
v_lshlrev_b32 v14, 3, v14
v_add_u32 v13, v13, v14
s_sub_u32 s64, s79, 49152
v_add_u32 v58, s64, v13
v_xor_b32 v59, 64, v58
v_subrev_u32 v60, 65536, v58
v_subrev_u32 v61, 65536, v59
v_subrev_u32 v62, 98304, v58
v_subrev_u32 v63, 98304, v59
v_mul_u32_u24 v57, 1152, v0
s_and_b32 s14, s24, 1
s_lshl_b32 s14, s14, 15
s_lshl_b32 s8, s14, 3
s_lshl_b32 s9, s101, 3
s_waitcnt vmcnt(7)
s_barrier
s_setprio 2
s_add_u32 m0, s70, 0
s_lshl_b32 s50, s77, 7
buffer_load_dwordx4 v2, s[32:35], s50 offen lds
s_addk_i32 m0, 0x400
s_addk_i32 s50, 0x4000
buffer_load_dwordx4 v3, s[32:35], s50 offen lds
s_addk_i32 m0, 0x400
s_addk_i32 s50, 0x4000
buffer_load_dwordx4 v2, s[32:35], s50 offen lds
s_addk_i32 m0, 0x400
s_addk_i32 s50, 0x4000
buffer_load_dwordx4 v3, s[32:35], s50 offen lds
s_add_u32 s77, s77, 1
s_add_u32 m0, s71, 90112
s_mul_i32 s50, s77, s73
buffer_load_dwordx4 v4, s[36:39], s50 offen lds
s_addk_i32 m0, 0x2000
s_add_u32 s50, s50, s75
buffer_load_dwordx4 v4, s[36:39], s50 offen lds
s_addk_i32 m0, 0x2000
s_add_u32 s50, s50, s75
buffer_load_dwordx4 v4, s[36:39], s50 offen lds
s_addk_i32 m0, 0x1000
s_add_u32 s50, s50, s74
buffer_load_dwordx4 v4, s[36:39], s50 offen lds
s_addk_i32 m0, -0x2000
s_sub_u32 s50, s50, s75
buffer_load_dwordx4 v4, s[36:39], s50 offen lds
s_addk_i32 m0, -0x2000
s_sub_u32 s50, s50, s75
buffer_load_dwordx4 v4, s[36:39], s50 offen lds
s_add_u32 m0, s72, 90112
s_mul_i32 s50, s77, s76
buffer_load_dwordx4 v5, s[40:43], s50 offen lds
s_add_u32 m0, s70, 90112
s_lshl_b32 s50, s77, 7
buffer_load_dwordx4 v2, s[32:35], s50 offen lds
s_addk_i32 m0, 0x400
s_addk_i32 s50, 0x4000
buffer_load_dwordx4 v3, s[32:35], s50 offen lds
s_addk_i32 m0, 0x400
s_addk_i32 s50, 0x4000
buffer_load_dwordx4 v2, s[32:35], s50 offen lds
s_addk_i32 m0, 0x400
s_addk_i32 s50, 0x4000
buffer_load_dwordx4 v3, s[32:35], s50 offen lds
s_add_u32 s77, s77, 1
s_sub_u32 m0, s79, 0
s_nop 0
buffer_load_dwordx4 v6, s[60:63], s8 offen lds
s_add_u32 s8, s8, 8192
s_add_u32 m0, s79, 1024
s_nop 0
buffer_load_dwordx4 v6, s[60:63], s8 offen lds
s_add_u32 s8, s8, 8192
s_add_u32 m0, s79, 2048
s_nop 0
buffer_load_dwordx4 v6, s[60:63], s8 offen lds
s_add_u32 s8, s8, 8192
s_add_u32 m0, s79, 3072
s_nop 0
buffer_load_dwordx4 v6, s[60:63], s8 offen lds
s_add_u32 s8, s8, 8192
s_cmp_ge_u32 s8, s9
s_cselect_b32 s8, 0, s8
s_waitcnt vmcnt(15)
s_barrier
s_add_u32 m0, s71, 45056
s_mul_i32 s50, s77, s73
buffer_load_dwordx4 v4, s[36:39], s50 offen lds
s_addk_i32 m0, 0x2000
s_add_u32 s50, s50, s75
buffer_load_dwordx4 v4, s[36:39], s50 offen lds
s_addk_i32 m0, 0x2000
s_add_u32 s50, s50, s75
buffer_load_dwordx4 v4, s[36:39], s50 offen lds
s_addk_i32 m0, 0x1000
s_add_u32 s50, s50, s74
buffer_load_dwordx4 v4, s[36:39], s50 offen lds
s_addk_i32 m0, -0x2000
s_sub_u32 s50, s50, s75
buffer_load_dwordx4 v4, s[36:39], s50 offen lds
s_addk_i32 m0, -0x2000
s_sub_u32 s50, s50, s75
buffer_load_dwordx4 v4, s[36:39], s50 offen lds
s_add_u32 m0, s72, 45056
s_mul_i32 s50, s77, s76
buffer_load_dwordx4 v5, s[40:43], s50 offen lds
s_add_u32 m0, s70, 45056
s_lshl_b32 s50, s77, 7
buffer_load_dwordx4 v2, s[32:35], s50 offen lds
s_addk_i32 m0, 0x400
s_addk_i32 s50, 0x4000
buffer_load_dwordx4 v3, s[32:35], s50 offen lds
s_addk_i32 m0, 0x400
s_addk_i32 s50, 0x4000
buffer_load_dwordx4 v2, s[32:35], s50 offen lds
s_addk_i32 m0, 0x400
s_addk_i32 s50, 0x4000
buffer_load_dwordx4 v3, s[32:35], s50 offen lds
s_add_u32 s77, s77, 1
s_waitcnt vmcnt(11)
ds_read_b64_tr_b16 v[72:73], v58 offset:49152
ds_read_b64_tr_b16 v[74:75], v58 offset:49664
ds_read_b64_tr_b16 v[76:77], v59 offset:49152
ds_read_b64_tr_b16 v[78:79], v59 offset:49664
ds_read_b64_tr_b16 v[80:81], v58 offset:51200
ds_read_b64_tr_b16 v[82:83], v58 offset:51712
ds_read_b64_tr_b16 v[84:85], v59 offset:51200
ds_read_b64_tr_b16 v[86:87], v59 offset:51712
s_waitcnt lgkmcnt(0)
s_sub_u32 m0, s79, 0
s_nop 0
buffer_load_dwordx4 v6, s[60:63], s8 offen lds
s_add_u32 s8, s8, 8192
s_add_u32 m0, s79, 1024
s_nop 0
buffer_load_dwordx4 v6, s[60:63], s8 offen lds
s_add_u32 s8, s8, 8192
s_add_u32 m0, s79, 2048
s_nop 0
buffer_load_dwordx4 v6, s[60:63], s8 offen lds
s_add_u32 s8, s8, 8192
s_add_u32 m0, s79, 3072
s_nop 0
buffer_load_dwordx4 v6, s[60:63], s8 offen lds
s_add_u32 s8, s8, 8192
s_cmp_ge_u32 s8, s9
s_cselect_b32 s8, 0, s8
s_waitcnt vmcnt(19)
s_barrier
s_add_u32 m0, s71, 0
s_mul_i32 s50, s77, s73
buffer_load_dwordx4 v4, s[36:39], s50 offen lds
s_addk_i32 m0, 0x2000
s_add_u32 s50, s50, s75
buffer_load_dwordx4 v4, s[36:39], s50 offen lds
s_addk_i32 m0, 0x2000
s_add_u32 s50, s50, s75
buffer_load_dwordx4 v4, s[36:39], s50 offen lds
s_addk_i32 m0, 0x1000
s_add_u32 s50, s50, s74
buffer_load_dwordx4 v4, s[36:39], s50 offen lds
s_addk_i32 m0, -0x2000
s_sub_u32 s50, s50, s75
buffer_load_dwordx4 v4, s[36:39], s50 offen lds
s_addk_i32 m0, -0x2000
s_sub_u32 s50, s50, s75
buffer_load_dwordx4 v4, s[36:39], s50 offen lds
s_add_u32 m0, s72, 0
s_mul_i32 s50, s77, s76
buffer_load_dwordx4 v5, s[40:43], s50 offen lds
s_add_u32 m0, s70, 0
s_lshl_b32 s50, s77, 7
buffer_load_dwordx4 v2, s[32:35], s50 offen lds
s_addk_i32 m0, 0x400
s_addk_i32 s50, 0x4000
buffer_load_dwordx4 v3, s[32:35], s50 offen lds
s_addk_i32 m0, 0x400
s_addk_i32 s50, 0x4000
buffer_load_dwordx4 v2, s[32:35], s50 offen lds
s_addk_i32 m0, 0x400
s_addk_i32 s50, 0x4000
buffer_load_dwordx4 v3, s[32:35], s50 offen lds
s_add_u32 s77, s77, 1
s_waitcnt vmcnt(11)
ds_read_b64_tr_b16 v[88:89], v58 offset:49152
ds_read_b64_tr_b16 v[90:91], v58 offset:49664
ds_read_b64_tr_b16 v[92:93], v59 offset:49152
ds_read_b64_tr_b16 v[94:95], v59 offset:49664
ds_read_b64_tr_b16 v[96:97], v58 offset:51200
ds_read_b64_tr_b16 v[98:99], v58 offset:51712
ds_read_b64_tr_b16 v[100:101], v59 offset:51200
ds_read_b64_tr_b16 v[102:103], v59 offset:51712
s_waitcnt lgkmcnt(0)
s_sub_u32 m0, s79, 0
s_nop 0
buffer_load_dwordx4 v6, s[60:63], s8 offen lds
s_add_u32 s8, s8, 8192
s_add_u32 m0, s79, 1024
s_nop 0
buffer_load_dwordx4 v6, s[60:63], s8 offen lds
s_add_u32 s8, s8, 8192
s_add_u32 m0, s79, 2048
s_nop 0
buffer_load_dwordx4 v6, s[60:63], s8 offen lds
s_add_u32 s8, s8, 8192
s_add_u32 m0, s79, 3072
s_nop 0
buffer_load_dwordx4 v6, s[60:63], s8 offen lds
s_add_u32 s8, s8, 8192
s_cmp_ge_u32 s8, s9
s_cselect_b32 s8, 0, s8
s_waitcnt vmcnt(19)
s_barrier
s_add_u32 m0, s71, 90112
s_mul_i32 s50, s77, s73
buffer_load_dwordx4 v4, s[36:39], s50 offen lds
s_addk_i32 m0, 0x2000
s_add_u32 s50, s50, s75
buffer_load_dwordx4 v4, s[36:39], s50 offen lds
s_addk_i32 m0, 0x2000
s_add_u32 s50, s50, s75
buffer_load_dwordx4 v4, s[36:39], s50 offen lds
s_addk_i32 m0, 0x1000
s_add_u32 s50, s50, s74
buffer_load_dwordx4 v4, s[36:39], s50 offen lds
s_addk_i32 m0, -0x2000
s_sub_u32 s50, s50, s75
buffer_load_dwordx4 v4, s[36:39], s50 offen lds
s_addk_i32 m0, -0x2000
s_sub_u32 s50, s50, s75
buffer_load_dwordx4 v4, s[36:39], s50 offen lds
s_add_u32 m0, s72, 90112
s_mul_i32 s50, s77, s76
buffer_load_dwordx4 v5, s[40:43], s50 offen lds
s_add_u32 m0, s70, 90112
s_lshl_b32 s50, s77, 7
buffer_load_dwordx4 v2, s[32:35], s50 offen lds
s_addk_i32 m0, 0x400
s_addk_i32 s50, 0x4000
buffer_load_dwordx4 v3, s[32:35], s50 offen lds
s_addk_i32 m0, 0x400
s_addk_i32 s50, 0x4000
buffer_load_dwordx4 v2, s[32:35], s50 offen lds
s_addk_i32 m0, 0x400
s_addk_i32 s50, 0x4000
buffer_load_dwordx4 v3, s[32:35], s50 offen lds
s_add_u32 s77, s77, 1
s_waitcnt vmcnt(15)
s_barrier
s_add_u32 m0, s71, 45056
s_mul_i32 s50, s77, s73
buffer_load_dwordx4 v4, s[36:39], s50 offen lds
s_addk_i32 m0, 0x2000
s_add_u32 s50, s50, s75
buffer_load_dwordx4 v4, s[36:39], s50 offen lds
s_addk_i32 m0, 0x2000
s_add_u32 s50, s50, s75
buffer_load_dwordx4 v4, s[36:39], s50 offen lds
s_addk_i32 m0, 0x1000
s_add_u32 s50, s50, s74
buffer_load_dwordx4 v4, s[36:39], s50 offen lds
s_addk_i32 m0, -0x2000
s_sub_u32 s50, s50, s75
buffer_load_dwordx4 v4, s[36:39], s50 offen lds
s_addk_i32 m0, -0x2000
s_sub_u32 s50, s50, s75
buffer_load_dwordx4 v4, s[36:39], s50 offen lds
s_add_u32 m0, s72, 45056
s_mul_i32 s50, s77, s76
buffer_load_dwordx4 v5, s[40:43], s50 offen lds
s_add_u32 m0, s70, 45056
s_lshl_b32 s50, s77, 7
buffer_load_dwordx4 v2, s[32:35], s50 offen lds
s_addk_i32 m0, 0x400
s_addk_i32 s50, 0x4000
buffer_load_dwordx4 v3, s[32:35], s50 offen lds
s_addk_i32 m0, 0x400
s_addk_i32 s50, 0x4000
buffer_load_dwordx4 v2, s[32:35], s50 offen lds
s_addk_i32 m0, 0x400
s_addk_i32 s50, 0x4000
buffer_load_dwordx4 v3, s[32:35], s50 offen lds
s_add_u32 s77, s77, 1
s_waitcnt vmcnt(11)
s_barrier
s_add_u32 m0, s71, 0
s_mul_i32 s50, s77, s73
buffer_load_dwordx4 v4, s[36:39], s50 offen lds
s_addk_i32 m0, 0x2000
s_add_u32 s50, s50, s75
buffer_load_dwordx4 v4, s[36:39], s50 offen lds
s_addk_i32 m0, 0x2000
s_add_u32 s50, s50, s75
buffer_load_dwordx4 v4, s[36:39], s50 offen lds
s_addk_i32 m0, 0x1000
s_add_u32 s50, s50, s74
buffer_load_dwordx4 v4, s[36:39], s50 offen lds
s_addk_i32 m0, -0x2000
s_sub_u32 s50, s50, s75
buffer_load_dwordx4 v4, s[36:39], s50 offen lds
s_addk_i32 m0, -0x2000
s_sub_u32 s50, s50, s75
buffer_load_dwordx4 v4, s[36:39], s50 offen lds
s_add_u32 m0, s72, 0
s_mul_i32 s50, s77, s76
buffer_load_dwordx4 v5, s[40:43], s50 offen lds
s_add_u32 m0, s70, 0
s_lshl_b32 s50, s77, 7
buffer_load_dwordx4 v2, s[32:35], s50 offen lds
s_addk_i32 m0, 0x400
s_addk_i32 s50, 0x4000
buffer_load_dwordx4 v3, s[32:35], s50 offen lds
s_addk_i32 m0, 0x400
s_addk_i32 s50, 0x4000
buffer_load_dwordx4 v2, s[32:35], s50 offen lds
s_addk_i32 m0, 0x400
s_addk_i32 s50, 0x4000
buffer_load_dwordx4 v3, s[32:35], s50 offen lds
s_add_u32 s77, s77, 1
s_waitcnt vmcnt(33)
ds_read_b64_tr_b16 v[104:105], v58 offset:49152
ds_read_b64_tr_b16 v[106:107], v58 offset:49664
ds_read_b64_tr_b16 v[108:109], v59 offset:49152
ds_read_b64_tr_b16 v[110:111], v59 offset:49664
ds_read_b64_tr_b16 v[112:113], v58 offset:51200
ds_read_b64_tr_b16 v[114:115], v58 offset:51712
ds_read_b64_tr_b16 v[116:117], v59 offset:51200
ds_read_b64_tr_b16 v[118:119], v59 offset:51712
s_waitcnt lgkmcnt(0)
s_sub_u32 m0, s79, 0
s_nop 0
buffer_load_dwordx4 v6, s[60:63], s8 offen lds
s_add_u32 s8, s8, 8192
s_add_u32 m0, s79, 1024
s_nop 0
buffer_load_dwordx4 v6, s[60:63], s8 offen lds
s_add_u32 s8, s8, 8192
s_add_u32 m0, s79, 2048
s_nop 0
buffer_load_dwordx4 v6, s[60:63], s8 offen lds
s_add_u32 s8, s8, 8192
s_add_u32 m0, s79, 3072
s_nop 0
buffer_load_dwordx4 v6, s[60:63], s8 offen lds
s_add_u32 s8, s8, 8192
s_cmp_ge_u32 s8, s9
s_cselect_b32 s8, 0, s8
s_mov_b32 s77, s14
s_mov_b32 s52, s18
s_mov_b32 s53, s19
s_mov_b32 s54, 2097152
s_mov_b32 s55, 0x20000
s_lshr_b32 s68, s28, 1
s_mul_i32 s68, s68, 18432
s_add_u32 s68, s68, 13762560
s_mov_b32 s48, 0x700
s_cmp_eq_u32 s27, 2
s_cselect_b32 s48, 0x3c00, s48
s_cmp_eq_u32 s27, 3
s_cselect_b32 s48, 0xe000, s48
s_cmp_eq_u32 s27, 0
s_cselect_b32 s48, 0xff, s48
s_mov_b32 s49, 0
s_lshl_b32 s69, s28, 9
s_lshl_b32 s64, s27, 7
s_add_u32 s69, s69, s64
s_add_u32 s69, s69, 13631488
s_waitcnt vmcnt(15)
s_barrier
s_sub_u32 m0, s79, 16384
s_nop 0
buffer_load_dwordx4 v6, s[60:63], s8 offen lds
s_add_u32 s8, s8, 8192
s_sub_u32 m0, s79, 15360
s_nop 0
buffer_load_dwordx4 v6, s[60:63], s8 offen lds
s_add_u32 s8, s8, 8192
s_sub_u32 m0, s79, 14336
s_nop 0
buffer_load_dwordx4 v6, s[60:63], s8 offen lds
s_add_u32 s8, s8, 8192
s_sub_u32 m0, s79, 13312
s_nop 0
buffer_load_dwordx4 v6, s[60:63], s8 offen lds
s_add_u32 s8, s8, 8192
s_cmp_ge_u32 s8, s9
s_cselect_b32 s8, 0, s8
s_sub_u32 m0, s79, 32768
s_nop 0
buffer_load_dwordx4 v6, s[60:63], s8 offen lds
s_add_u32 s8, s8, 8192
s_sub_u32 m0, s79, 31744
s_nop 0
buffer_load_dwordx4 v6, s[60:63], s8 offen lds
s_add_u32 s8, s8, 8192
s_sub_u32 m0, s79, 30720
s_nop 0
buffer_load_dwordx4 v6, s[60:63], s8 offen lds
s_add_u32 s8, s8, 8192
s_sub_u32 m0, s79, 29696
s_nop 0
buffer_load_dwordx4 v6, s[60:63], s8 offen lds
s_add_u32 s8, s8, 8192
s_cmp_ge_u32 s8, s9
s_cselect_b32 s8, 0, s8
s_sub_u32 m0, s79, 49152
s_nop 0
buffer_load_dwordx4 v6, s[60:63], s8 offen lds
s_add_u32 s8, s8, 8192
s_sub_u32 m0, s79, 48128
s_nop 0
buffer_load_dwordx4 v6, s[60:63], s8 offen lds
s_add_u32 s8, s8, 8192
s_sub_u32 m0, s79, 47104
s_nop 0
buffer_load_dwordx4 v6, s[60:63], s8 offen lds
s_add_u32 s8, s8, 8192
s_sub_u32 m0, s79, 46080
s_nop 0
buffer_load_dwordx4 v6, s[60:63], s8 offen lds
s_add_u32 s8, s8, 8192
s_cmp_ge_u32 s8, s9
s_cselect_b32 s8, 0, s8
s_waitcnt vmcnt(16)
s_barrier
s_sub_u32 m0, s79, 65536
s_nop 0
buffer_load_dwordx4 v6, s[60:63], s8 offen lds
s_add_u32 s8, s8, 8192
s_sub_u32 m0, s79, 64512
s_nop 0
buffer_load_dwordx4 v6, s[60:63], s8 offen lds
s_add_u32 s8, s8, 8192
s_sub_u32 m0, s79, 63488
s_nop 0
buffer_load_dwordx4 v6, s[60:63], s8 offen lds
s_add_u32 s8, s8, 8192
s_sub_u32 m0, s79, 62464
s_nop 0
buffer_load_dwordx4 v6, s[60:63], s8 offen lds
s_add_u32 s8, s8, 8192
s_cmp_ge_u32 s8, s9
s_cselect_b32 s8, 0, s8
s_sub_u32 m0, s79, 81920
s_nop 0
buffer_load_dwordx4 v6, s[60:63], s8 offen lds
s_add_u32 s8, s8, 8192
s_sub_u32 m0, s79, 80896
s_nop 0
buffer_load_dwordx4 v6, s[60:63], s8 offen lds
s_add_u32 s8, s8, 8192
s_sub_u32 m0, s79, 79872
s_nop 0
buffer_load_dwordx4 v6, s[60:63], s8 offen lds
s_add_u32 s8, s8, 8192
s_sub_u32 m0, s79, 78848
s_nop 0
buffer_load_dwordx4 v6, s[60:63], s8 offen lds
s_add_u32 s8, s8, 8192
s_cmp_ge_u32 s8, s9
s_cselect_b32 s8, 0, s8
s_sub_u32 m0, s79, 98304
s_nop 0
buffer_load_dwordx4 v6, s[60:63], s8 offen lds
s_add_u32 s8, s8, 8192
s_sub_u32 m0, s79, 97280
s_nop 0
buffer_load_dwordx4 v6, s[60:63], s8 offen lds
s_add_u32 s8, s8, 8192
s_sub_u32 m0, s79, 96256
s_nop 0
buffer_load_dwordx4 v6, s[60:63], s8 offen lds
s_add_u32 s8, s8, 8192
s_sub_u32 m0, s79, 95232
s_nop 0
buffer_load_dwordx4 v6, s[60:63], s8 offen lds
s_add_u32 s8, s8, 8192
s_cmp_ge_u32 s8, s9
s_cselect_b32 s8, 0, s8
s_waitcnt vmcnt(16)
ds_read_b64_tr_b16 v[120:121], v58 offset:49152
ds_read_b64_tr_b16 v[122:123], v58 offset:49664
ds_read_b64_tr_b16 v[124:125], v59 offset:49152
ds_read_b64_tr_b16 v[126:127], v59 offset:49664
ds_read_b64_tr_b16 v[128:129], v58 offset:51200
ds_read_b64_tr_b16 v[130:131], v58 offset:51712
ds_read_b64_tr_b16 v[132:133], v59 offset:51200
ds_read_b64_tr_b16 v[134:135], v59 offset:51712
ds_read_b64_tr_b16 v[136:137], v58 offset:32768
ds_read_b64_tr_b16 v[138:139], v58 offset:33280
ds_read_b64_tr_b16 v[140:141], v59 offset:32768
ds_read_b64_tr_b16 v[142:143], v59 offset:33280
ds_read_b64_tr_b16 v[144:145], v58 offset:34816
ds_read_b64_tr_b16 v[146:147], v58 offset:35328
ds_read_b64_tr_b16 v[148:149], v59 offset:34816
ds_read_b64_tr_b16 v[150:151], v59 offset:35328
ds_read_b64_tr_b16 v[152:153], v58 offset:16384
ds_read_b64_tr_b16 v[154:155], v58 offset:16896
ds_read_b64_tr_b16 v[156:157], v59 offset:16384
ds_read_b64_tr_b16 v[158:159], v59 offset:16896
ds_read_b64_tr_b16 v[160:161], v58 offset:18432
ds_read_b64_tr_b16 v[162:163], v58 offset:18944
ds_read_b64_tr_b16 v[164:165], v59 offset:18432
ds_read_b64_tr_b16 v[166:167], v59 offset:18944
s_barrier
global_load_dwordx2 v[10:11], v7, s[20:21] sc1
s_sub_u32 m0, s79, 114688
s_nop 0
buffer_load_dwordx4 v6, s[60:63], s8 offen lds
s_add_u32 s8, s8, 8192
s_sub_u32 m0, s79, 113664
s_nop 0
buffer_load_dwordx4 v6, s[60:63], s8 offen lds
s_add_u32 s8, s8, 8192
s_sub_u32 m0, s79, 112640
s_nop 0
buffer_load_dwordx4 v6, s[60:63], s8 offen lds
s_add_u32 s8, s8, 8192
s_sub_u32 m0, s79, 111616
s_nop 0
buffer_load_dwordx4 v6, s[60:63], s8 offen lds
s_add_u32 s8, s8, 8192
s_cmp_ge_u32 s8, s9
s_cselect_b32 s8, 0, s8
s_waitcnt vmcnt(13)
ds_read_b64_tr_b16 v[168:169], v58 offset:0
ds_read_b64_tr_b16 v[170:171], v58 offset:512
ds_read_b64_tr_b16 v[172:173], v59 offset:0
ds_read_b64_tr_b16 v[174:175], v59 offset:512
ds_read_b64_tr_b16 v[176:177], v58 offset:2048
ds_read_b64_tr_b16 v[178:179], v58 offset:2560
ds_read_b64_tr_b16 v[180:181], v59 offset:2048
ds_read_b64_tr_b16 v[182:183], v59 offset:2560
ds_read_b64_tr_b16 v[184:185], v60 offset:49152
ds_read_b64_tr_b16 v[186:187], v60 offset:49664
ds_read_b64_tr_b16 v[188:189], v61 offset:49152
ds_read_b64_tr_b16 v[190:191], v61 offset:49664
ds_read_b64_tr_b16 v[192:193], v60 offset:51200
ds_read_b64_tr_b16 v[194:195], v60 offset:51712
ds_read_b64_tr_b16 v[196:197], v61 offset:51200
ds_read_b64_tr_b16 v[198:199], v61 offset:51712
s_waitcnt vmcnt(4)
s_mov_b32 s64, 0x40000
TAGL_7:
v_readfirstlane_b32 s30, v10
v_readfirstlane_b32 s31, v11
s_nop 0
s_cmp_lg_u32 s30, 0
s_cbranch_scc1 TAGD_8
s_sub_u32 s64, s64, 1
s_cmp_eq_u32 s64, 0
s_cbranch_scc1 TAGD_8
s_sleep 2
global_load_dwordx2 v[10:11], v7, s[20:21] sc1
s_waitcnt vmcnt(0)
s_branch TAGL_7
TAGD_8:
v_mov_b32 v2, v62
v_mov_b32 v3, v63
v_lshrrev_b32 v7, 4, v0
v_lshlrev_b32 v7, 4, v7
s_cmp_eq_u32 s25, 0
s_cbranch_scc1 KL_NOSB
s_barrier
KL_NOSB:
s_sub_u32 m0, s79, 131072
s_nop 0
buffer_load_dwordx4 v6, s[60:63], s8 offen lds
s_add_u32 s8, s8, 8192
s_sub_u32 m0, s79, 130048
s_nop 0
buffer_load_dwordx4 v6, s[60:63], s8 offen lds
s_add_u32 s8, s8, 8192
s_sub_u32 m0, s79, 129024
s_nop 0
buffer_load_dwordx4 v6, s[60:63], s8 offen lds
s_add_u32 s8, s8, 8192
s_sub_u32 m0, s79, 128000
s_nop 0
buffer_load_dwordx4 v6, s[60:63], s8 offen lds
s_add_u32 s8, s8, 8192
s_cmp_ge_u32 s8, s9
s_cselect_b32 s8, 0, s8
s_cmp_eq_u32 s27, 0
s_cbranch_scc1 KL_SK9
s_sub_u32 m0, s79, 147456
s_nop 0
buffer_load_dwordx4 v6, s[60:63], s8 offen lds
s_add_u32 s8, s8, 8192
s_sub_u32 m0, s79, 146432
s_nop 0
buffer_load_dwordx4 v6, s[60:63], s8 offen lds
s_add_u32 s8, s8, 8192
s_sub_u32 m0, s79, 145408
s_nop 0
buffer_load_dwordx4 v6, s[60:63], s8 offen lds
s_add_u32 s8, s8, 8192
s_sub_u32 m0, s79, 144384
s_nop 0
buffer_load_dwordx4 v6, s[60:63], s8 offen lds
s_add_u32 s8, s8, 8192
s_cmp_ge_u32 s8, s9
s_cselect_b32 s8, 0, s8
KL_SK9:
s_waitcnt lgkmcnt(0)
s_waitcnt vmcnt(13)
ds_read_b64_tr_b16 v[200:201], v60 offset:32768
ds_read_b64_tr_b16 v[202:203], v60 offset:33280
ds_read_b64_tr_b16 v[204:205], v61 offset:32768
ds_read_b64_tr_b16 v[206:207], v61 offset:33280
ds_read_b64_tr_b16 v[208:209], v60 offset:34816
ds_read_b64_tr_b16 v[210:211], v60 offset:35328
ds_read_b64_tr_b16 v[212:213], v61 offset:34816
ds_read_b64_tr_b16 v[214:215], v61 offset:35328
s_sub_u32 m0, s79, 0
s_nop 0
buffer_load_dwordx4 v6, s[60:63], s8 offen lds
s_add_u32 s8, s8, 8192
s_add_u32 m0, s79, 1024
s_nop 0
buffer_load_dwordx4 v6, s[60:63], s8 offen lds
s_add_u32 s8, s8, 8192
s_add_u32 m0, s79, 2048
s_nop 0
buffer_load_dwordx4 v6, s[60:63], s8 offen lds
s_add_u32 s8, s8, 8192
s_add_u32 m0, s79, 3072
s_nop 0
buffer_load_dwordx4 v6, s[60:63], s8 offen lds
s_add_u32 s8, s8, 8192
s_cmp_ge_u32 s8, s9
s_cselect_b32 s8, 0, s8
s_sub_u32 m0, s79, 16384
s_nop 0
buffer_load_dwordx4 v6, s[60:63], s8 offen lds
s_add_u32 s8, s8, 8192
s_sub_u32 m0, s79, 15360
s_nop 0
buffer_load_dwordx4 v6, s[60:63], s8 offen lds
s_add_u32 s8, s8, 8192
s_sub_u32 m0, s79, 14336
s_nop 0
buffer_load_dwordx4 v6, s[60:63], s8 offen lds
s_add_u32 s8, s8, 8192
s_sub_u32 m0, s79, 13312
s_nop 0
buffer_load_dwordx4 v6, s[60:63], s8 offen lds
s_add_u32 s8, s8, 8192
s_cmp_ge_u32 s8, s9
s_cselect_b32 s8, 0, s8
s_cmp_lg_u32 s25, 0
s_cbranch_scc1 KL_NOSA
s_barrier
KL_NOSA:
s_sub_u32 m0, s79, 32768
s_nop 0
buffer_load_dwordx4 v6, s[60:63], s8 offen lds
s_add_u32 s8, s8, 8192
s_sub_u32 m0, s79, 31744
s_nop 0
buffer_load_dwordx4 v6, s[60:63], s8 offen lds
s_add_u32 s8, s8, 8192
s_sub_u32 m0, s79, 30720
s_nop 0
buffer_load_dwordx4 v6, s[60:63], s8 offen lds
s_add_u32 s8, s8, 8192
s_sub_u32 m0, s79, 29696
s_nop 0
buffer_load_dwordx4 v6, s[60:63], s8 offen lds
s_add_u32 s8, s8, 8192
s_cmp_ge_u32 s8, s9
s_cselect_b32 s8, 0, s8
s_sub_u32 m0, s79, 49152
s_nop 0
buffer_load_dwordx4 v6, s[60:63], s8 offen lds
s_add_u32 s8, s8, 8192
s_sub_u32 m0, s79, 48128
s_nop 0
buffer_load_dwordx4 v6, s[60:63], s8 offen lds
s_add_u32 s8, s8, 8192
s_sub_u32 m0, s79, 47104
s_nop 0
buffer_load_dwordx4 v6, s[60:63], s8 offen lds
s_add_u32 s8, s8, 8192
s_sub_u32 m0, s79, 46080
s_nop 0
buffer_load_dwordx4 v6, s[60:63], s8 offen lds
s_add_u32 s8, s8, 8192
s_cmp_ge_u32 s8, s9
s_cselect_b32 s8, 0, s8
s_mov_b64 exec, s[48:49]
buffer_load_dwordx2 v[8:9], v57, s[44:47], s68 offen sc1
s_mov_b64 exec, -1
s_waitcnt lgkmcnt(0)
s_cmp_eq_u32 s27, 0
s_cbranch_scc1 KL_W0
s_sub_u32 m0, s79, 65536
s_nop 0
buffer_load_dwordx4 v6, s[60:63], s8 offen lds
s_add_u32 s8, s8, 8192
s_sub_u32 m0, s79, 64512
s_nop 0
buffer_load_dwordx4 v6, s[60:63], s8 offen lds
s_add_u32 s8, s8, 8192
s_sub_u32 m0, s79, 63488
s_nop 0
buffer_load_dwordx4 v6, s[60:63], s8 offen lds
s_add_u32 s8, s8, 8192
s_sub_u32 m0, s79, 62464
s_nop 0
buffer_load_dwordx4 v6, s[60:63], s8 offen lds
s_add_u32 s8, s8, 8192
s_cmp_ge_u32 s8, s9
s_cselect_b32 s8, 0, s8
s_cmp_eq_u32 s27, 3
s_cbranch_scc1 KL_W1
s_sub_u32 m0, s79, 81920
s_nop 0
buffer_load_dwordx4 v6, s[60:63], s8 offen lds
s_add_u32 s8, s8, 8192
s_sub_u32 m0, s79, 80896
s_nop 0
buffer_load_dwordx4 v6, s[60:63], s8 offen lds
s_add_u32 s8, s8, 8192
s_sub_u32 m0, s79, 79872
s_nop 0
buffer_load_dwordx4 v6, s[60:63], s8 offen lds
s_add_u32 s8, s8, 8192
s_sub_u32 m0, s79, 78848
s_nop 0
buffer_load_dwordx4 v6, s[60:63], s8 offen lds
s_add_u32 s8, s8, 8192
s_cmp_ge_u32 s8, s9
s_cselect_b32 s8, 0, s8
s_waitcnt vmcnt(8)
v_cmp_eq_u64 vcc, s[30:31], v[8:9]
s_nop 0
s_andn2_b64 s[64:65], s[48:49], vcc
s_cbranch_scc0 KL_V19
s_branch KL_SLOW
KL_W0:
s_waitcnt vmcnt(0)
v_cmp_eq_u64 vcc, s[30:31], v[8:9]
s_nop 0
s_andn2_b64 s[64:65], s[48:49], vcc
s_cbranch_scc0 KL_V16
s_branch KL_SLOW
KL_W1:
s_waitcnt vmcnt(4)
v_cmp_eq_u64 vcc, s[30:31], v[8:9]
s_nop 0
s_andn2_b64 s[64:65], s[48:49], vcc
s_cbranch_scc0 KL_V18
KL_SLOW:
s_mov_b64 exec, s[48:49]
s_mov_b32 s66, 0x40000
POLL_9:
buffer_load_dwordx2 v[8:9], v57, s[44:47], s68 offen sc1
s_waitcnt vmcnt(0)
POLC_10:
v_cmp_eq_u64 vcc, s[30:31], v[8:9]
s_nop 0
s_andn2_b64 s[64:65], s[48:49], vcc
s_cbranch_scc0 POLD_11
s_sub_u32 s66, s66, 1
s_cmp_eq_u32 s66, 0
s_cbranch_scc1 POLD_11
s_sleep 1
s_branch POLL_9
POLD_11:
s_mov_b64 exec, -1
s_cmp_eq_u32 s27, 0
s_cbranch_scc1 KL_V16
s_cmp_eq_u32 s27, 3
s_cbranch_scc1 KL_V18
.p2align 3
KL_V19:
buffer_load_dwordx4 v[216:219], v1, s[56:59], s77 offen offset:0 sc1
buffer_load_dwordx4 v[220:223], v1, s[56:59], s77 offen offset:1024 sc1
buffer_load_dwordx4 v[224:227], v1, s[56:59], s77 offen offset:2048 sc1
buffer_load_dwordx4 v[228:231], v1, s[56:59], s77 offen offset:3072 sc1
s_add_u32 s77, s77, 4096
s_cmp_ge_u32 s77, s101
s_cselect_b32 s77, 0, s77
buffer_load_dwordx4 v[232:235], v1, s[56:59], s77 offen offset:0 sc1
buffer_load_dwordx4 v[236:239], v1, s[56:59], s77 offen offset:1024 sc1
buffer_load_dwordx4 v[240:243], v1, s[56:59], s77 offen offset:2048 sc1
buffer_load_dwordx4 v[244:247], v1, s[56:59], s77 offen offset:3072 sc1
s_add_u32 s77, s77, 4096
s_cmp_ge_u32 s77, s101
s_cselect_b32 s77, 0, s77
buffer_load_dwordx4 v[248:251], v1, s[56:59], s77 offen offset:0 sc1
buffer_load_dwordx4 v[252:255], v1, s[56:59], s77 offen offset:1024 sc1
s_waitcnt vmcnt(9)
s_nop 0
v_mfma_f32_32x32x16_bf16 v[8:23], v[72:75], v[216:219], 0
v_mfma_f32_32x32x16_bf16 v[24:39], v[76:79], v[216:219], 0
buffer_load_dwordx4 v[216:219], v1, s[56:59], s77 offen offset:2048 sc1
s_waitcnt vmcnt(9)
s_nop 0
v_mfma_f32_32x32x16_bf16 v[40:55], v[72:75], v[220:223], 0
v_mfma_f32_32x32x16_bf16 v[56:71], v[76:79], v[220:223], 0
buffer_load_dwordx4 v[220:223], v1, s[56:59], s77 offen offset:3072 sc1
s_waitcnt vmcnt(9)
s_nop 0
v_mfma_f32_32x32x16_bf16 v[8:23], v[80:83], v[224:227], v[8:23]
v_mfma_f32_32x32x16_bf16 v[24:39], v[84:87], v[224:227], v[24:39]
s_add_u32 s77, s77, 4096
s_cmp_ge_u32 s77, s101
s_cselect_b32 s77, 0, s77
buffer_load_dwordx4 v[224:227], v1, s[56:59], s77 offen offset:0 sc1
s_waitcnt vmcnt(9)
s_nop 0
v_mfma_f32_32x32x16_bf16 v[40:55], v[80:83], v[228:231], v[40:55]
v_mfma_f32_32x32x16_bf16 v[56:71], v[84:87], v[228:231], v[56:71]
buffer_load_dwordx4 v[228:231], v1, s[56:59], s77 offen offset:1024 sc1
s_waitcnt vmcnt(9)
s_nop 0
v_mfma_f32_32x32x16_bf16 v[8:23], v[88:91], v[232:235], v[8:23]
v_mfma_f32_32x32x16_bf16 v[24:39], v[92:95], v[232:235], v[24:39]
buffer_load_dwordx4 v[232:235], v1, s[56:59], s77 offen offset:2048 sc1
s_waitcnt vmcnt(9)
s_nop 0
v_mfma_f32_32x32x16_bf16 v[40:55], v[88:91], v[236:239], v[40:55]
v_mfma_f32_32x32x16_bf16 v[56:71], v[92:95], v[236:239], v[56:71]
buffer_load_dwordx4 v[236:239], v1, s[56:59], s77 offen offset:3072 sc1
s_waitcnt vmcnt(9)
s_nop 0
v_mfma_f32_32x32x16_bf16 v[8:23], v[96:99], v[240:243], v[8:23]
v_mfma_f32_32x32x16_bf16 v[24:39], v[100:103], v[240:243], v[24:39]
s_add_u32 s77, s77, 4096
s_cmp_ge_u32 s77, s101
s_cselect_b32 s77, 0, s77
buffer_load_dwordx4 v[240:243], v1, s[56:59], s77 offen offset:0 sc1
s_waitcnt vmcnt(9)
s_nop 0
v_mfma_f32_32x32x16_bf16 v[40:55], v[96:99], v[244:247], v[40:55]
v_mfma_f32_32x32x16_bf16 v[56:71], v[100:103], v[244:247], v[56:71]
buffer_load_dwordx4 v[244:247], v1, s[56:59], s77 offen offset:1024 sc1
s_waitcnt vmcnt(9)
s_nop 0
v_mfma_f32_32x32x16_bf16 v[8:23], v[104:107], v[248:251], v[8:23]
s_lshr_b32 s64, s28, 1
s_lshl_b32 s64, s64, 7
s_lshl_b32 s65, s27, 5
.p2align 3
v_mfma_f32_32x32x16_bf16 v[24:39], v[108:111], v[248:251], v[24:39]
buffer_load_dwordx4 v[248:251], v1, s[56:59], s77 offen offset:2048 sc1
s_waitcnt vmcnt(9)
s_nop 0
v_mfma_f32_32x32x16_bf16 v[40:55], v[104:107], v[252:255], v[40:55]
buffer_load_dwordx4 v[104:107], v1, s[56:59], s77 offen offset:3072 sc1
v_mfma_f32_32x32x16_bf16 v[56:71], v[108:111], v[252:255], v[56:71]
s_add_u32 s64, s64, s65
s_and_b32 s65, s28, 1
s_add_u32 s64, s64, s65
.p2align 3
s_waitcnt vmcnt(9)
s_nop 0
v_mfma_f32_32x32x16_bf16 v[8:23], v[112:115], v[216:219], v[8:23]
s_add_u32 s77, s77, 4096
s_cmp_ge_u32 s77, s101
s_cselect_b32 s77, 0, s77
buffer_load_dwordx4 v[252:255], v1, s[56:59], s77 offen offset:0 sc1
v_mfma_f32_32x32x16_bf16 v[24:39], v[116:119], v[216:219], v[24:39]
s_lshl_b32 s64, s64, 10
s_lshl_b32 s65, s29, 7
s_add_u32 s70, s64, s65
.p2align 3
s_waitcnt vmcnt(9)
s_nop 0
v_mfma_f32_32x32x16_bf16 v[40:55], v[112:115], v[220:223], v[40:55]
buffer_load_dwordx4 v[108:111], v1, s[56:59], s77 offen offset:1024 sc1
v_mfma_f32_32x32x16_bf16 v[56:71], v[116:119], v[220:223], v[56:71]
s_add_u32 s71, s70, 16384
s_sub_u32 s72, s79, 32768
s_lshl_b32 s73, s27, 14
.p2align 3
s_waitcnt vmcnt(9)
s_nop 0
v_mfma_f32_32x32x16_bf16 v[8:23], v[120:123], v[224:227], v[8:23]
buffer_load_dwordx4 v[216:219], v1, s[56:59], s77 offen offset:2048 sc1
v_mfma_f32_32x32x16_bf16 v[24:39], v[124:127], v[224:227], v[24:39]
s_sub_u32 s73, 131072, s73
v_and_b32 v93, 15, v0
v_lshrrev_b32 v94, 5, v0
.p2align 3
s_waitcnt vmcnt(9)
s_nop 0
v_mfma_f32_32x32x16_bf16 v[40:55], v[120:123], v[228:231], v[40:55]
buffer_load_dwordx4 v[112:115], v1, s[56:59], s77 offen offset:3072 sc1
v_mfma_f32_32x32x16_bf16 v[56:71], v[124:127], v[228:231], v[56:71]
v_xor_b32 v94, v94, v93
v_lshlrev_b32 v94, 4, v94
v_lshlrev_b32 v95, 8, v93
.p2align 3
s_waitcnt vmcnt(9)
s_nop 0
v_mfma_f32_32x32x16_bf16 v[8:23], v[128:131], v[232:235], v[8:23]
s_add_u32 s77, s77, 4096
s_cmp_ge_u32 s77, s101
s_cselect_b32 s77, 0, s77
buffer_load_dwordx4 v[220:223], v1, s[56:59], s77 offen offset:0 sc1
v_mfma_f32_32x32x16_bf16 v[24:39], v[132:135], v[232:235], v[24:39]
v_add_u32 v94, v94, v95
v_bfe_u32 v95, v0, 4, 1
v_lshlrev_b32 v95, 14, v95
.p2align 3
s_waitcnt vmcnt(9)
s_nop 0
v_mfma_f32_32x32x16_bf16 v[40:55], v[128:131], v[236:239], v[40:55]
buffer_load_dwordx4 v[116:119], v1, s[56:59], s77 offen offset:1024 sc1
v_mfma_f32_32x32x16_bf16 v[56:71], v[132:135], v[236:239], v[56:71]
v_sub_u32 v94, v94, v95
v_add_u32 v80, s72, v94
v_xor_b32 v81, 32, v80
.p2align 3
s_waitcnt vmcnt(9)
s_nop 0
v_mfma_f32_32x32x16_bf16 v[8:23], v[136:139], v[240:243], v[8:23]
buffer_load_dwordx4 v[224:227], v1, s[56:59], s77 offen offset:2048 sc1
v_mfma_f32_32x32x16_bf16 v[24:39], v[140:143], v[240:243], v[24:39]
v_xor_b32 v82, 64, v80
v_xor_b32 v83, 96, v80
v_xor_b32 v84, 128, v80
.p2align 3
s_waitcnt vmcnt(9)
s_nop 0
v_mfma_f32_32x32x16_bf16 v[40:55], v[136:139], v[244:247], v[40:55]
buffer_load_dwordx4 v[120:123], v1, s[56:59], s77 offen offset:3072 sc1
v_mfma_f32_32x32x16_bf16 v[56:71], v[140:143], v[244:247], v[56:71]
v_xor_b32 v85, 160, v80
v_xor_b32 v86, 192, v80
v_xor_b32 v87, 224, v80
.p2align 3
s_waitcnt vmcnt(9)
s_nop 0
v_mfma_f32_32x32x16_bf16 v[8:23], v[144:147], v[248:251], v[8:23]
s_add_u32 s77, s77, 4096
s_cmp_ge_u32 s77, s101
s_cselect_b32 s77, 0, s77
buffer_load_dwordx4 v[228:231], v1, s[56:59], s77 offen offset:0 sc1
v_mfma_f32_32x32x16_bf16 v[24:39], v[148:151], v[248:251], v[24:39]
v_lshrrev_b32 v93, 3, v0
v_and_b32 v94, 7, v0
v_lshlrev_b32 v92, 11, v93
.p2align 3
s_waitcnt vmcnt(9)
s_nop 0
v_mfma_f32_32x32x16_bf16 v[40:55], v[144:147], v[104:107], v[40:55]
buffer_load_dwordx4 v[124:127], v1, s[56:59], s77 offen offset:1024 sc1
v_mfma_f32_32x32x16_bf16 v[56:71], v[148:151], v[104:107], v[56:71]
v_lshlrev_b32 v95, 4, v94
v_add_u32 v92, v92, v95
v_lshlrev_b32 v95, 1, v94
.p2align 3
s_waitcnt vmcnt(9)
s_nop 0
v_mfma_f32_32x32x16_bf16 v[8:23], v[152:155], v[252:255], v[8:23]
buffer_load_dwordx4 v[232:235], v1, s[56:59], s77 offen offset:2048 sc1
v_mfma_f32_32x32x16_bf16 v[24:39], v[156:159], v[252:255], v[24:39]
v_xor_b32 v95, v95, v93
v_lshlrev_b32 v95, 4, v95
v_lshlrev_b32 v93, 8, v93
.p2align 3
s_waitcnt vmcnt(9)
s_nop 0
v_mfma_f32_32x32x16_bf16 v[40:55], v[152:155], v[108:111], v[40:55]
buffer_load_dwordx4 v[128:131], v1, s[56:59], s77 offen offset:3072 sc1
v_mfma_f32_32x32x16_bf16 v[56:71], v[156:159], v[108:111], v[56:71]
v_add_u32 v95, v95, v93
v_add_u32 v88, s73, v95
v_xor_b32 v89, 16, v88
.p2align 3
s_waitcnt vmcnt(9)
s_nop 0
v_mfma_f32_32x32x16_bf16 v[8:23], v[160:163], v[216:219], v[8:23]
s_add_u32 s77, s77, 4096
s_cmp_ge_u32 s77, s101
s_cselect_b32 s77, 0, s77
buffer_load_dwordx4 v[236:239], v1, s[56:59], s77 offen offset:0 sc1
v_mfma_f32_32x32x16_bf16 v[24:39], v[164:167], v[216:219], v[24:39]
v_xor_b32 v90, 128, v88
v_xor_b32 v91, 144, v88
v_and_b32 v93, 8, v0
.p2align 3
s_waitcnt vmcnt(9)
s_nop 0
v_mfma_f32_32x32x16_bf16 v[40:55], v[160:163], v[112:115], v[40:55]
buffer_load_dwordx4 v[132:135], v1, s[56:59], s77 offen offset:1024 sc1
v_mfma_f32_32x32x16_bf16 v[56:71], v[164:167], v[112:115], v[56:71]
v_cmp_ne_u32 s[74:75], 0, v93
s_lshl_b32 s72, s27, 9
s_add_u32 s72, s72, 160768
.p2align 3
s_waitcnt vmcnt(9)
s_nop 0
v_mfma_f32_32x32x16_bf16 v[8:23], v[168:171], v[220:223], v[8:23]
buffer_load_dwordx4 v[240:243], v1, s[56:59], s77 offen offset:2048 sc1
v_mfma_f32_32x32x16_bf16 v[24:39], v[172:175], v[220:223], v[24:39]
v_lshlrev_b32 v103, 3, v0
v_add_u32 v103, s72, v103
.p2align 3
s_waitcnt vmcnt(9)
s_nop 0
v_mfma_f32_32x32x16_bf16 v[40:55], v[168:171], v[116:119], v[40:55]
buffer_load_dwordx4 v[136:139], v1, s[56:59], s77 offen offset:3072 sc1
v_mfma_f32_32x32x16_bf16 v[56:71], v[172:175], v[116:119], v[56:71]
s_waitcnt vmcnt(9)
s_nop 0
v_mfma_f32_32x32x16_bf16 v[8:23], v[176:179], v[224:227], v[8:23]
s_add_u32 s77, s77, 4096
s_cmp_ge_u32 s77, s101
s_cselect_b32 s77, 0, s77
buffer_load_dwordx4 v[244:247], v1, s[56:59], s77 offen offset:0 sc1
v_mfma_f32_32x32x16_bf16 v[24:39], v[180:183], v[224:227], v[24:39]
s_waitcnt vmcnt(9)
s_nop 0
v_mfma_f32_32x32x16_bf16 v[40:55], v[176:179], v[120:123], v[40:55]
buffer_load_dwordx4 v[140:143], v1, s[56:59], s77 offen offset:1024 sc1
v_mfma_f32_32x32x16_bf16 v[56:71], v[180:183], v[120:123], v[56:71]
v_add_u32 v2, 0x8000, v2
v_add_u32 v3, 0x8000, v3
s_waitcnt vmcnt(9)
s_nop 0
v_mfma_f32_32x32x16_bf16 v[8:23], v[184:187], v[228:231], v[8:23]
buffer_load_dwordx4 v[248:251], v1, s[56:59], s77 offen offset:2048 sc1
v_mfma_f32_32x32x16_bf16 v[24:39], v[188:191], v[228:231], v[24:39]
s_waitcnt vmcnt(9)
s_nop 0
v_mfma_f32_32x32x16_bf16 v[40:55], v[184:187], v[124:127], v[40:55]
ds_read_b64_tr_b16 v[184:185], v2 offset:16384
ds_read_b64_tr_b16 v[186:187], v2 offset:16896
buffer_load_dwordx4 v[144:147], v1, s[56:59], s77 offen offset:3072 sc1
v_mfma_f32_32x32x16_bf16 v[56:71], v[188:191], v[124:127], v[56:71]
ds_read_b64_tr_b16 v[188:189], v3 offset:16384
ds_read_b64_tr_b16 v[190:191], v3 offset:16896
s_waitcnt vmcnt(9)
s_nop 0
v_mfma_f32_32x32x16_bf16 v[8:23], v[192:195], v[232:235], v[8:23]
s_add_u32 s77, s77, 4096
s_cmp_ge_u32 s77, s101
s_cselect_b32 s77, 0, s77
buffer_load_dwordx4 v[104:107], v1, s[56:59], s77 offen offset:0 sc1
v_mfma_f32_32x32x16_bf16 v[24:39], v[196:199], v[232:235], v[24:39]
s_waitcnt vmcnt(9)
s_nop 0
v_mfma_f32_32x32x16_bf16 v[40:55], v[192:195], v[128:131], v[40:55]
ds_read_b64_tr_b16 v[192:193], v2 offset:18432
ds_read_b64_tr_b16 v[194:195], v2 offset:18944
buffer_load_dwordx4 v[148:151], v1, s[56:59], s77 offen offset:1024 sc1
v_mfma_f32_32x32x16_bf16 v[56:71], v[196:199], v[128:131], v[56:71]
ds_read_b64_tr_b16 v[196:197], v3 offset:18432
ds_read_b64_tr_b16 v[198:199], v3 offset:18944
s_waitcnt vmcnt(9)
s_nop 0
v_mfma_f32_32x32x16_bf16 v[8:23], v[200:203], v[236:239], v[8:23]
buffer_load_dwordx4 v[252:255], v1, s[56:59], s77 offen offset:2048 sc1
v_mfma_f32_32x32x16_bf16 v[24:39], v[204:207], v[236:239], v[24:39]
s_waitcnt vmcnt(9)
s_nop 0
v_mfma_f32_32x32x16_bf16 v[40:55], v[200:203], v[132:135], v[40:55]
ds_read_b64_tr_b16 v[200:201], v2 offset:0
ds_read_b64_tr_b16 v[202:203], v2 offset:512
buffer_load_dwordx4 v[152:155], v1, s[56:59], s77 offen offset:3072 sc1
v_mfma_f32_32x32x16_bf16 v[56:71], v[204:207], v[132:135], v[56:71]
ds_read_b64_tr_b16 v[204:205], v3 offset:0
ds_read_b64_tr_b16 v[206:207], v3 offset:512
s_waitcnt vmcnt(9)
s_nop 0
v_mfma_f32_32x32x16_bf16 v[8:23], v[208:211], v[240:243], v[8:23]
s_add_u32 s77, s77, 4096
s_cmp_ge_u32 s77, s101
s_cselect_b32 s77, 0, s77
buffer_load_dwordx4 v[108:111], v1, s[56:59], s77 offen offset:0 sc1
v_mfma_f32_32x32x16_bf16 v[24:39], v[212:215], v[240:243], v[24:39]
s_waitcnt vmcnt(9)
s_nop 0
v_mfma_f32_32x32x16_bf16 v[40:55], v[208:211], v[136:139], v[40:55]
ds_read_b64_tr_b16 v[208:209], v2 offset:2048
ds_read_b64_tr_b16 v[210:211], v2 offset:2560
buffer_load_dwordx4 v[156:159], v1, s[56:59], s77 offen offset:1024 sc1
v_mfma_f32_32x32x16_bf16 v[56:71], v[212:215], v[136:139], v[56:71]
ds_read_b64_tr_b16 v[212:213], v3 offset:2048
ds_read_b64_tr_b16 v[214:215], v3 offset:2560
v_add_u32 v2, 0xffff8000, v2
v_add_u32 v3, 0xffff8000, v3
s_waitcnt vmcnt(9) lgkmcnt(12)
s_nop 0
v_mfma_f32_32x32x16_bf16 v[8:23], v[184:187], v[244:247], v[8:23]
buffer_load_dwordx4 v[216:219], v1, s[56:59], s77 offen offset:2048 sc1
v_mfma_f32_32x32x16_bf16 v[24:39], v[188:191], v[244:247], v[24:39]
s_waitcnt vmcnt(9)
s_nop 0
v_mfma_f32_32x32x16_bf16 v[40:55], v[184:187], v[140:143], v[40:55]
ds_read_b64_tr_b16 v[184:185], v2 offset:16384
ds_read_b64_tr_b16 v[186:187], v2 offset:16896
buffer_load_dwordx4 v[160:163], v1, s[56:59], s77 offen offset:3072 sc1
v_mfma_f32_32x32x16_bf16 v[56:71], v[188:191], v[140:143], v[56:71]
ds_read_b64_tr_b16 v[188:189], v3 offset:16384
ds_read_b64_tr_b16 v[190:191], v3 offset:16896
s_waitcnt vmcnt(9) lgkmcnt(12)
s_nop 0
v_mfma_f32_32x32x16_bf16 v[8:23], v[192:195], v[248:251], v[8:23]
s_add_u32 s77, s77, 4096
s_cmp_ge_u32 s77, s101
s_cselect_b32 s77, 0, s77
buffer_load_dwordx4 v[112:115], v1, s[56:59], s77 offen offset:0 sc1
v_mfma_f32_32x32x16_bf16 v[24:39], v[196:199], v[248:251], v[24:39]
s_waitcnt vmcnt(9)
s_nop 0
v_mfma_f32_32x32x16_bf16 v[40:55], v[192:195], v[144:147], v[40:55]
ds_read_b64_tr_b16 v[192:193], v2 offset:18432
ds_read_b64_tr_b16 v[194:195], v2 offset:18944
buffer_load_dwordx4 v[164:167], v1, s[56:59], s77 offen offset:1024 sc1
v_mfma_f32_32x32x16_bf16 v[56:71], v[196:199], v[144:147], v[56:71]
ds_read_b64_tr_b16 v[196:197], v3 offset:18432
ds_read_b64_tr_b16 v[198:199], v3 offset:18944
s_waitcnt vmcnt(9) lgkmcnt(12)
s_nop 0
v_mfma_f32_32x32x16_bf16 v[8:23], v[200:203], v[104:107], v[8:23]
buffer_load_dwordx4 v[220:223], v1, s[56:59], s77 offen offset:2048 sc1
v_mfma_f32_32x32x16_bf16 v[24:39], v[204:207], v[104:107], v[24:39]
s_waitcnt vmcnt(9)
s_nop 0
v_mfma_f32_32x32x16_bf16 v[40:55], v[200:203], v[148:151], v[40:55]
ds_read_b64_tr_b16 v[200:201], v2 offset:0
ds_read_b64_tr_b16 v[202:203], v2 offset:512
buffer_load_dwordx4 v[168:171], v1, s[56:59], s77 offen offset:3072 sc1
v_mfma_f32_32x32x16_bf16 v[56:71], v[204:207], v[148:151], v[56:71]
ds_read_b64_tr_b16 v[204:205], v3 offset:0
ds_read_b64_tr_b16 v[206:207], v3 offset:512
s_waitcnt vmcnt(9) lgkmcnt(12)
s_nop 0
v_mfma_f32_32x32x16_bf16 v[8:23], v[208:211], v[252:255], v[8:23]
buffer_load_dwordx4 v[72:75], v7, s[44:47], s69 offen offset:0 sc1
v_mfma_f32_32x32x16_bf16 v[24:39], v[212:215], v[252:255], v[24:39]
s_waitcnt vmcnt(9)
s_nop 0
v_mfma_f32_32x32x16_bf16 v[40:55], v[208:211], v[152:155], v[40:55]
ds_read_b64_tr_b16 v[208:209], v2 offset:2048
ds_read_b64_tr_b16 v[210:211], v2 offset:2560
buffer_load_dwordx4 v[76:79], v7, s[44:47], s69 offen offset:64 sc1
v_mfma_f32_32x32x16_bf16 v[56:71], v[212:215], v[152:155], v[56:71]
ds_read_b64_tr_b16 v[212:213], v3 offset:2048
ds_read_b64_tr_b16 v[214:215], v3 offset:2560
v_add_u32 v2, 0x18000, v2
v_add_u32 v3, 0x18000, v3
s_waitcnt vmcnt(9) lgkmcnt(12)
s_nop 0
v_mfma_f32_32x32x16_bf16 v[8:23], v[184:187], v[108:111], v[8:23]
s_add_u32 s77, s77, 4096
s_cmp_ge_u32 s77, s101
s_cselect_b32 s77, 0, s77
buffer_load_dwordx4 v[116:119], v1, s[56:59], s77 offen offset:0 sc1
v_mfma_f32_32x32x16_bf16 v[24:39], v[188:191], v[108:111], v[24:39]
s_waitcnt vmcnt(9)
s_nop 0
v_mfma_f32_32x32x16_bf16 v[40:55], v[184:187], v[156:159], v[40:55]
ds_read_b64_tr_b16 v[184:185], v2 offset:49152
ds_read_b64_tr_b16 v[186:187], v2 offset:49664
buffer_load_dwordx4 v[172:175], v1, s[56:59], s77 offen offset:1024 sc1
v_mfma_f32_32x32x16_bf16 v[56:71], v[188:191], v[156:159], v[56:71]
ds_read_b64_tr_b16 v[188:189], v3 offset:49152
ds_read_b64_tr_b16 v[190:191], v3 offset:49664
s_waitcnt vmcnt(9) lgkmcnt(12)
s_nop 0
v_mfma_f32_32x32x16_bf16 v[8:23], v[192:195], v[216:219], v[8:23]
buffer_load_dwordx4 v[224:227], v1, s[56:59], s77 offen offset:2048 sc1
v_mfma_f32_32x32x16_bf16 v[24:39], v[196:199], v[216:219], v[24:39]
s_waitcnt vmcnt(9)
s_nop 0
v_mfma_f32_32x32x16_bf16 v[40:55], v[192:195], v[160:163], v[40:55]
ds_read_b64_tr_b16 v[192:193], v2 offset:51200
ds_read_b64_tr_b16 v[194:195], v2 offset:51712
buffer_load_dwordx4 v[176:179], v1, s[56:59], s77 offen offset:3072 sc1
v_mfma_f32_32x32x16_bf16 v[56:71], v[196:199], v[160:163], v[56:71]
ds_read_b64_tr_b16 v[196:197], v3 offset:51200
ds_read_b64_tr_b16 v[198:199], v3 offset:51712
s_waitcnt vmcnt(9) lgkmcnt(12)
s_nop 0
v_mfma_f32_32x32x16_bf16 v[8:23], v[200:203], v[112:115], v[8:23]
s_add_u32 s77, s77, 4096
s_cmp_ge_u32 s77, s101
s_cselect_b32 s77, 0, s77
buffer_load_dwordx4 v[120:123], v1, s[56:59], s77 offen offset:0 sc1
v_mfma_f32_32x32x16_bf16 v[24:39], v[204:207], v[112:115], v[24:39]
s_waitcnt vmcnt(9)
s_nop 0
v_mfma_f32_32x32x16_bf16 v[40:55], v[200:203], v[164:167], v[40:55]
ds_read_b64_tr_b16 v[200:201], v2 offset:32768
ds_read_b64_tr_b16 v[202:203], v2 offset:33280
buffer_load_dwordx4 v[180:183], v1, s[56:59], s77 offen offset:1024 sc1
v_mfma_f32_32x32x16_bf16 v[56:71], v[204:207], v[164:167], v[56:71]
ds_read_b64_tr_b16 v[204:205], v3 offset:32768
ds_read_b64_tr_b16 v[206:207], v3 offset:33280
s_waitcnt vmcnt(9) lgkmcnt(12)
s_nop 0
v_mfma_f32_32x32x16_bf16 v[8:23], v[208:211], v[220:223], v[8:23]
buffer_load_dwordx4 v[228:231], v1, s[56:59], s77 offen offset:2048 sc1
v_mfma_f32_32x32x16_bf16 v[24:39], v[212:215], v[220:223], v[24:39]
s_waitcnt vmcnt(9)
s_nop 0
v_mfma_f32_32x32x16_bf16 v[40:55], v[208:211], v[168:171], v[40:55]
ds_read_b64_tr_b16 v[208:209], v2 offset:34816
ds_read_b64_tr_b16 v[210:211], v2 offset:35328
buffer_load_dwordx4 v[124:127], v1, s[56:59], s77 offen offset:3072 sc1
v_mfma_f32_32x32x16_bf16 v[56:71], v[212:215], v[168:171], v[56:71]
ds_read_b64_tr_b16 v[212:213], v3 offset:34816
ds_read_b64_tr_b16 v[214:215], v3 offset:35328
s_waitcnt vmcnt(7) lgkmcnt(12)
s_nop 0
v_mfma_f32_32x32x16_bf16 v[8:23], v[184:187], v[116:119], v[8:23]
s_add_u32 s77, s77, 4096
s_cmp_ge_u32 s77, s101
s_cselect_b32 s77, 0, s77
buffer_load_dwordx4 v[232:235], v1, s[56:59], s77 offen offset:0 sc1
v_mfma_f32_32x32x16_bf16 v[24:39], v[188:191], v[116:119], v[24:39]
buffer_load_dwordx4 v[128:131], v1, s[56:59], s77 offen offset:1024 sc1
s_waitcnt vmcnt(8)
s_nop 0
v_mfma_f32_32x32x16_bf16 v[40:55], v[184:187], v[172:175], v[40:55]
ds_read_b64_tr_b16 v[184:185], v2 offset:16384
ds_read_b64_tr_b16 v[186:187], v2 offset:16896
buffer_load_dwordx4 v[236:239], v1, s[56:59], s77 offen offset:2048 sc1
v_mfma_f32_32x32x16_bf16 v[56:71], v[188:191], v[172:175], v[56:71]
ds_read_b64_tr_b16 v[188:189], v3 offset:16384
ds_read_b64_tr_b16 v[190:191], v3 offset:16896
buffer_load_dwordx4 v[132:135], v1, s[56:59], s77 offen offset:3072 sc1
s_waitcnt vmcnt(9) lgkmcnt(12)
s_nop 0
v_mfma_f32_32x32x16_bf16 v[8:23], v[192:195], v[224:227], v[8:23]
s_add_u32 s77, s77, 4096
s_cmp_ge_u32 s77, s101
s_cselect_b32 s77, 0, s77
buffer_load_dwordx4 v[240:243], v1, s[56:59], s77 offen offset:0 sc1
v_mfma_f32_32x32x16_bf16 v[24:39], v[196:199], v[224:227], v[24:39]
s_waitcnt vmcnt(9)
s_nop 0
v_mfma_f32_32x32x16_bf16 v[40:55], v[192:195], v[176:179], v[40:55]
ds_read_b64_tr_b16 v[192:193], v2 offset:18432
ds_read_b64_tr_b16 v[194:195], v2 offset:18944
buffer_load_dwordx4 v[136:139], v1, s[56:59], s77 offen offset:1024 sc1
v_mfma_f32_32x32x16_bf16 v[56:71], v[196:199], v[176:179], v[56:71]
ds_read_b64_tr_b16 v[196:197], v3 offset:18432
ds_read_b64_tr_b16 v[198:199], v3 offset:18944
s_waitcnt vmcnt(9) lgkmcnt(12)
s_nop 0
v_mfma_f32_32x32x16_bf16 v[8:23], v[200:203], v[120:123], v[8:23]
buffer_load_dwordx4 v[244:247], v1, s[56:59], s77 offen offset:2048 sc1
v_mfma_f32_32x32x16_bf16 v[24:39], v[204:207], v[120:123], v[24:39]
s_waitcnt vmcnt(9)
s_nop 0
v_mfma_f32_32x32x16_bf16 v[40:55], v[200:203], v[180:183], v[40:55]
ds_read_b64_tr_b16 v[200:201], v2 offset:0
ds_read_b64_tr_b16 v[202:203], v2 offset:512
buffer_load_dwordx4 v[140:143], v1, s[56:59], s77 offen offset:3072 sc1
v_mfma_f32_32x32x16_bf16 v[56:71], v[204:207], v[180:183], v[56:71]
ds_read_b64_tr_b16 v[204:205], v3 offset:0
ds_read_b64_tr_b16 v[206:207], v3 offset:512
s_waitcnt vmcnt(9) lgkmcnt(12)
s_nop 0
v_mfma_f32_32x32x16_bf16 v[8:23], v[208:211], v[228:231], v[8:23]
s_add_u32 s77, s77, 4096
s_cmp_ge_u32 s77, s101
s_cselect_b32 s77, 0, s77
buffer_load_dwordx4 v[248:251], v1, s[56:59], s77 offen offset:0 sc1
v_mfma_f32_32x32x16_bf16 v[24:39], v[212:215], v[228:231], v[24:39]
s_waitcnt vmcnt(9)
s_nop 0
v_mfma_f32_32x32x16_bf16 v[40:55], v[208:211], v[124:127], v[40:55]
ds_read_b64_tr_b16 v[208:209], v2 offset:2048
ds_read_b64_tr_b16 v[210:211], v2 offset:2560
buffer_load_dwordx4 v[144:147], v1, s[56:59], s77 offen offset:1024 sc1
v_mfma_f32_32x32x16_bf16 v[56:71], v[212:215], v[124:127], v[56:71]
ds_read_b64_tr_b16 v[212:213], v3 offset:2048
ds_read_b64_tr_b16 v[214:215], v3 offset:2560
v_add_u32 v2, 0xffff0000, v2
v_add_u32 v3, 0xffff0000, v3
s_waitcnt vmcnt(9) lgkmcnt(12)
s_nop 0
v_mfma_f32_32x32x16_bf16 v[8:23], v[184:187], v[232:235], v[8:23]
buffer_load_dwordx4 v[104:107], v1, s[56:59], s77 offen offset:2048 sc1
v_mfma_f32_32x32x16_bf16 v[24:39], v[188:191], v[232:235], v[24:39]
s_waitcnt vmcnt(9)
s_nop 0
v_mfma_f32_32x32x16_bf16 v[40:55], v[184:187], v[128:131], v[40:55]
ds_read_b64_tr_b16 v[184:185], v2 offset:49152
ds_read_b64_tr_b16 v[186:187], v2 offset:49664
buffer_load_dwordx4 v[148:151], v1, s[56:59], s77 offen offset:3072 sc1
v_mfma_f32_32x32x16_bf16 v[56:71], v[188:191], v[128:131], v[56:71]
ds_read_b64_tr_b16 v[188:189], v3 offset:49152
ds_read_b64_tr_b16 v[190:191], v3 offset:49664
s_waitcnt vmcnt(9) lgkmcnt(12)
s_nop 0
v_mfma_f32_32x32x16_bf16 v[8:23], v[192:195], v[236:239], v[8:23]
s_add_u32 s77, s77, 4096
s_cmp_ge_u32 s77, s101
s_cselect_b32 s77, 0, s77
buffer_load_dwordx4 v[252:255], v1, s[56:59], s77 offen offset:0 sc1
v_mfma_f32_32x32x16_bf16 v[24:39], v[196:199], v[236:239], v[24:39]
s_waitcnt vmcnt(9)
s_nop 0
v_mfma_f32_32x32x16_bf16 v[40:55], v[192:195], v[132:135], v[40:55]
ds_read_b64_tr_b16 v[192:193], v2 offset:51200
ds_read_b64_tr_b16 v[194:195], v2 offset:51712
buffer_load_dwordx4 v[152:155], v1, s[56:59], s77 offen offset:1024 sc1
v_mfma_f32_32x32x16_bf16 v[56:71], v[196:199], v[132:135], v[56:71]
ds_read_b64_tr_b16 v[196:197], v3 offset:51200
ds_read_b64_tr_b16 v[198:199], v3 offset:51712
s_waitcnt vmcnt(9) lgkmcnt(12)
s_nop 0
v_mfma_f32_32x32x16_bf16 v[8:23], v[200:203], v[240:243], v[8:23]
buffer_load_dwordx4 v[108:111], v1, s[56:59], s77 offen offset:2048 sc1
v_mfma_f32_32x32x16_bf16 v[24:39], v[204:207], v[240:243], v[24:39]
s_waitcnt vmcnt(9)
s_nop 0
v_mfma_f32_32x32x16_bf16 v[40:55], v[200:203], v[136:139], v[40:55]
ds_read_b64_tr_b16 v[200:201], v2 offset:32768
ds_read_b64_tr_b16 v[202:203], v2 offset:33280
buffer_load_dwordx4 v[156:159], v1, s[56:59], s77 offen offset:3072 sc1
v_mfma_f32_32x32x16_bf16 v[56:71], v[204:207], v[136:139], v[56:71]
ds_read_b64_tr_b16 v[204:205], v3 offset:32768
ds_read_b64_tr_b16 v[206:207], v3 offset:33280
s_waitcnt vmcnt(9) lgkmcnt(12)
s_nop 0
v_mfma_f32_32x32x16_bf16 v[8:23], v[208:211], v[244:247], v[8:23]
v_mfma_f32_32x32x16_bf16 v[24:39], v[212:215], v[244:247], v[24:39]
s_waitcnt vmcnt(8)
s_nop 0
v_mfma_f32_32x32x16_bf16 v[40:55], v[208:211], v[140:143], v[40:55]
ds_read_b64_tr_b16 v[208:209], v2 offset:34816
ds_read_b64_tr_b16 v[210:211], v2 offset:35328
v_mfma_f32_32x32x16_bf16 v[56:71], v[212:215], v[140:143], v[56:71]
ds_read_b64_tr_b16 v[212:213], v3 offset:34816
ds_read_b64_tr_b16 v[214:215], v3 offset:35328
s_waitcnt vmcnt(7) lgkmcnt(12)
s_nop 0
v_mfma_f32_32x32x16_bf16 v[8:23], v[184:187], v[248:251], v[8:23]
v_mfma_f32_32x32x16_bf16 v[24:39], v[188:191], v[248:251], v[24:39]
s_waitcnt vmcnt(6)
s_nop 0
v_mfma_f32_32x32x16_bf16 v[40:55], v[184:187], v[144:147], v[40:55]
v_mfma_f32_32x32x16_bf16 v[56:71], v[188:191], v[144:147], v[56:71]
s_waitcnt vmcnt(5) lgkmcnt(8)
s_nop 0
v_mfma_f32_32x32x16_bf16 v[8:23], v[192:195], v[104:107], v[8:23]
v_mfma_f32_32x32x16_bf16 v[24:39], v[196:199], v[104:107], v[24:39]
s_waitcnt vmcnt(4)
s_nop 0
v_mfma_f32_32x32x16_bf16 v[40:55], v[192:195], v[148:151], v[40:55]
v_mfma_f32_32x32x16_bf16 v[56:71], v[196:199], v[148:151], v[56:71]
s_waitcnt vmcnt(0) lgkmcnt(0)
s_nop 0
v_mfma_f32_32x32x16_bf16 v[8:23], v[200:203], v[252:255], v[8:23]
v_mfma_f32_32x32x16_bf16 v[8:23], v[208:211], v[108:111], v[8:23]
v_mfma_f32_32x32x16_bf16 v[24:39], v[204:207], v[252:255], v[24:39]
v_cndmask_b32 v96, v72, v73, s[74:75]
v_cndmask_b32 v98, v76, v77, s[74:75]
v_sub_f32 v100, 1.0, v96
v_sub_f32 v101, 1.0, v98
v_cvt_pk_bf16_f32 v100, v100, v101
v_mfma_f32_32x32x16_bf16 v[24:39], v[212:215], v[108:111], v[24:39]
v_and_b32 v102, 0xffff0000, v100
v_lshlrev_b32 v100, 16, v100
v_cmp_eq_u64 vcc, s[30:31], v[74:75]
v_cmp_eq_u64 s[64:65], s[30:31], v[78:79]
v_mfma_f32_32x32x16_bf16 v[40:55], v[200:203], v[152:155], v[40:55]
ds_write_b128 v80, v[8:11] offset:32768
ds_write_b128 v81, v[12:15] offset:32768
ds_write_b128 v82, v[16:19] offset:32768
ds_write_b128 v83, v[20:23] offset:32768
v_mfma_f32_32x32x16_bf16 v[40:55], v[208:211], v[156:159], v[40:55]
s_nop 1
ds_write_b128 v84, v[24:27] offset:32768
ds_write_b128 v85, v[28:31] offset:32768
v_mfma_f32_32x32x16_bf16 v[56:71], v[204:207], v[152:155], v[56:71]
ds_write_b128 v86, v[32:35] offset:32768
ds_write_b128 v87, v[36:39] offset:32768
v_mfma_f32_32x32x16_bf16 v[56:71], v[212:215], v[156:159], v[56:71]
s_nop 3
ds_write_b128 v80, v[40:43] offset:0
ds_write_b128 v81, v[44:47] offset:0
ds_write_b128 v82, v[48:51] offset:0
ds_write_b128 v83, v[52:55] offset:0
s_nop 3
ds_write_b128 v84, v[56:59] offset:0
ds_write_b128 v85, v[60:63] offset:0
ds_write_b128 v86, v[64:67] offset:0
ds_write_b128 v87, v[68:71] offset:0
s_branch KL_FIN
.p2align 3
KL_V18:
buffer_load_dwordx4 v[216:219], v1, s[56:59], s77 offen offset:0 sc1
buffer_load_dwordx4 v[220:223], v1, s[56:59], s77 offen offset:1024 sc1
buffer_load_dwordx4 v[224:227], v1, s[56:59], s77 offen offset:2048 sc1
buffer_load_dwordx4 v[228:231], v1, s[56:59], s77 offen offset:3072 sc1
s_add_u32 s77, s77, 4096
s_cmp_ge_u32 s77, s101
s_cselect_b32 s77, 0, s77
buffer_load_dwordx4 v[232:235], v1, s[56:59], s77 offen offset:0 sc1
buffer_load_dwordx4 v[236:239], v1, s[56:59], s77 offen offset:1024 sc1
buffer_load_dwordx4 v[240:243], v1, s[56:59], s77 offen offset:2048 sc1
buffer_load_dwordx4 v[244:247], v1, s[56:59], s77 offen offset:3072 sc1
s_add_u32 s77, s77, 4096
s_cmp_ge_u32 s77, s101
s_cselect_b32 s77, 0, s77
buffer_load_dwordx4 v[248:251], v1, s[56:59], s77 offen offset:0 sc1
buffer_load_dwordx4 v[252:255], v1, s[56:59], s77 offen offset:1024 sc1
s_waitcnt vmcnt(9)
s_nop 0
v_mfma_f32_32x32x16_bf16 v[8:23], v[72:75], v[216:219], 0
v_mfma_f32_32x32x16_bf16 v[24:39], v[76:79], v[216:219], 0
buffer_load_dwordx4 v[216:219], v1, s[56:59], s77 offen offset:2048 sc1
s_waitcnt vmcnt(9)
s_nop 0
v_mfma_f32_32x32x16_bf16 v[40:55], v[72:75], v[220:223], 0
v_mfma_f32_32x32x16_bf16 v[56:71], v[76:79], v[220:223], 0
buffer_load_dwordx4 v[220:223], v1, s[56:59], s77 offen offset:3072 sc1
s_waitcnt vmcnt(9)
s_nop 0
v_mfma_f32_32x32x16_bf16 v[8:23], v[80:83], v[224:227], v[8:23]
v_mfma_f32_32x32x16_bf16 v[24:39], v[84:87], v[224:227], v[24:39]
s_add_u32 s77, s77, 4096
s_cmp_ge_u32 s77, s101
s_cselect_b32 s77, 0, s77
buffer_load_dwordx4 v[224:227], v1, s[56:59], s77 offen offset:0 sc1
s_waitcnt vmcnt(9)
s_nop 0
v_mfma_f32_32x32x16_bf16 v[40:55], v[80:83], v[228:231], v[40:55]
v_mfma_f32_32x32x16_bf16 v[56:71], v[84:87], v[228:231], v[56:71]
buffer_load_dwordx4 v[228:231], v1, s[56:59], s77 offen offset:1024 sc1
s_waitcnt vmcnt(9)
s_nop 0
v_mfma_f32_32x32x16_bf16 v[8:23], v[88:91], v[232:235], v[8:23]
v_mfma_f32_32x32x16_bf16 v[24:39], v[92:95], v[232:235], v[24:39]
buffer_load_dwordx4 v[232:235], v1, s[56:59], s77 offen offset:2048 sc1
s_waitcnt vmcnt(9)
s_nop 0
v_mfma_f32_32x32x16_bf16 v[40:55], v[88:91], v[236:239], v[40:55]
v_mfma_f32_32x32x16_bf16 v[56:71], v[92:95], v[236:239], v[56:71]
buffer_load_dwordx4 v[236:239], v1, s[56:59], s77 offen offset:3072 sc1
s_waitcnt vmcnt(9)
s_nop 0
v_mfma_f32_32x32x16_bf16 v[8:23], v[96:99], v[240:243], v[8:23]
v_mfma_f32_32x32x16_bf16 v[24:39], v[100:103], v[240:243], v[24:39]
s_add_u32 s77, s77, 4096
s_cmp_ge_u32 s77, s101
s_cselect_b32 s77, 0, s77
buffer_load_dwordx4 v[240:243], v1, s[56:59], s77 offen offset:0 sc1
s_waitcnt vmcnt(9)
s_nop 0
v_mfma_f32_32x32x16_bf16 v[40:55], v[96:99], v[244:247], v[40:55]
v_mfma_f32_32x32x16_bf16 v[56:71], v[100:103], v[244:247], v[56:71]
buffer_load_dwordx4 v[244:247], v1, s[56:59], s77 offen offset:1024 sc1
s_waitcnt vmcnt(9)
s_nop 0
v_mfma_f32_32x32x16_bf16 v[8:23], v[104:107], v[248:251], v[8:23]
s_lshr_b32 s64, s28, 1
s_lshl_b32 s64, s64, 7
s_lshl_b32 s65, s27, 5
.p2align 3
v_mfma_f32_32x32x16_bf16 v[24:39], v[108:111], v[248:251], v[24:39]
buffer_load_dwordx4 v[248:251], v1, s[56:59], s77 offen offset:2048 sc1
s_waitcnt vmcnt(9)
s_nop 0
v_mfma_f32_32x32x16_bf16 v[40:55], v[104:107], v[252:255], v[40:55]
buffer_load_dwordx4 v[104:107], v1, s[56:59], s77 offen offset:3072 sc1
v_mfma_f32_32x32x16_bf16 v[56:71], v[108:111], v[252:255], v[56:71]
s_add_u32 s64, s64, s65
s_and_b32 s65, s28, 1
s_add_u32 s64, s64, s65
.p2align 3
s_waitcnt vmcnt(9)
s_nop 0
v_mfma_f32_32x32x16_bf16 v[8:23], v[112:115], v[216:219], v[8:23]
s_add_u32 s77, s77, 4096
s_cmp_ge_u32 s77, s101
s_cselect_b32 s77, 0, s77
buffer_load_dwordx4 v[252:255], v1, s[56:59], s77 offen offset:0 sc1
v_mfma_f32_32x32x16_bf16 v[24:39], v[116:119], v[216:219], v[24:39]
s_lshl_b32 s64, s64, 10
s_lshl_b32 s65, s29, 7
s_add_u32 s70, s64, s65
.p2align 3
s_waitcnt vmcnt(9)
s_nop 0
v_mfma_f32_32x32x16_bf16 v[40:55], v[112:115], v[220:223], v[40:55]
buffer_load_dwordx4 v[108:111], v1, s[56:59], s77 offen offset:1024 sc1
v_mfma_f32_32x32x16_bf16 v[56:71], v[116:119], v[220:223], v[56:71]
s_add_u32 s71, s70, 16384
s_sub_u32 s72, s79, 32768
s_lshl_b32 s73, s27, 14
.p2align 3
s_waitcnt vmcnt(9)
s_nop 0
v_mfma_f32_32x32x16_bf16 v[8:23], v[120:123], v[224:227], v[8:23]
buffer_load_dwordx4 v[216:219], v1, s[56:59], s77 offen offset:2048 sc1
v_mfma_f32_32x32x16_bf16 v[24:39], v[124:127], v[224:227], v[24:39]
s_sub_u32 s73, 131072, s73
v_and_b32 v93, 15, v0
v_lshrrev_b32 v94, 5, v0
.p2align 3
s_waitcnt vmcnt(9)
s_nop 0
v_mfma_f32_32x32x16_bf16 v[40:55], v[120:123], v[228:231], v[40:55]
buffer_load_dwordx4 v[112:115], v1, s[56:59], s77 offen offset:3072 sc1
v_mfma_f32_32x32x16_bf16 v[56:71], v[124:127], v[228:231], v[56:71]
v_xor_b32 v94, v94, v93
v_lshlrev_b32 v94, 4, v94
v_lshlrev_b32 v95, 8, v93
.p2align 3
s_waitcnt vmcnt(9)
s_nop 0
v_mfma_f32_32x32x16_bf16 v[8:23], v[128:131], v[232:235], v[8:23]
s_add_u32 s77, s77, 4096
s_cmp_ge_u32 s77, s101
s_cselect_b32 s77, 0, s77
buffer_load_dwordx4 v[220:223], v1, s[56:59], s77 offen offset:0 sc1
v_mfma_f32_32x32x16_bf16 v[24:39], v[132:135], v[232:235], v[24:39]
v_add_u32 v94, v94, v95
v_bfe_u32 v95, v0, 4, 1
v_lshlrev_b32 v95, 14, v95
.p2align 3
s_waitcnt vmcnt(9)
s_nop 0
v_mfma_f32_32x32x16_bf16 v[40:55], v[128:131], v[236:239], v[40:55]
buffer_load_dwordx4 v[116:119], v1, s[56:59], s77 offen offset:1024 sc1
v_mfma_f32_32x32x16_bf16 v[56:71], v[132:135], v[236:239], v[56:71]
v_sub_u32 v94, v94, v95
v_add_u32 v80, s72, v94
v_xor_b32 v81, 32, v80
.p2align 3
s_waitcnt vmcnt(9)
s_nop 0
v_mfma_f32_32x32x16_bf16 v[8:23], v[136:139], v[240:243], v[8:23]
buffer_load_dwordx4 v[224:227], v1, s[56:59], s77 offen offset:2048 sc1
v_mfma_f32_32x32x16_bf16 v[24:39], v[140:143], v[240:243], v[24:39]
v_xor_b32 v82, 64, v80
v_xor_b32 v83, 96, v80
v_xor_b32 v84, 128, v80
.p2align 3
s_waitcnt vmcnt(9)
s_nop 0
v_mfma_f32_32x32x16_bf16 v[40:55], v[136:139], v[244:247], v[40:55]
buffer_load_dwordx4 v[120:123], v1, s[56:59], s77 offen offset:3072 sc1
v_mfma_f32_32x32x16_bf16 v[56:71], v[140:143], v[244:247], v[56:71]
v_xor_b32 v85, 160, v80
v_xor_b32 v86, 192, v80
v_xor_b32 v87, 224, v80
.p2align 3
s_waitcnt vmcnt(9)
s_nop 0
v_mfma_f32_32x32x16_bf16 v[8:23], v[144:147], v[248:251], v[8:23]
s_add_u32 s77, s77, 4096
s_cmp_ge_u32 s77, s101
s_cselect_b32 s77, 0, s77
buffer_load_dwordx4 v[228:231], v1, s[56:59], s77 offen offset:0 sc1
v_mfma_f32_32x32x16_bf16 v[24:39], v[148:151], v[248:251], v[24:39]
v_lshrrev_b32 v93, 3, v0
v_and_b32 v94, 7, v0
v_lshlrev_b32 v92, 11, v93
.p2align 3
s_waitcnt vmcnt(9)
s_nop 0
v_mfma_f32_32x32x16_bf16 v[40:55], v[144:147], v[104:107], v[40:55]
buffer_load_dwordx4 v[124:127], v1, s[56:59], s77 offen offset:1024 sc1
v_mfma_f32_32x32x16_bf16 v[56:71], v[148:151], v[104:107], v[56:71]
v_lshlrev_b32 v95, 4, v94
v_add_u32 v92, v92, v95
v_lshlrev_b32 v95, 1, v94
.p2align 3
s_waitcnt vmcnt(9)
s_nop 0
v_mfma_f32_32x32x16_bf16 v[8:23], v[152:155], v[252:255], v[8:23]
buffer_load_dwordx4 v[232:235], v1, s[56:59], s77 offen offset:2048 sc1
v_mfma_f32_32x32x16_bf16 v[24:39], v[156:159], v[252:255], v[24:39]
v_xor_b32 v95, v95, v93
v_lshlrev_b32 v95, 4, v95
v_lshlrev_b32 v93, 8, v93
.p2align 3
s_waitcnt vmcnt(9)
s_nop 0
v_mfma_f32_32x32x16_bf16 v[40:55], v[152:155], v[108:111], v[40:55]
buffer_load_dwordx4 v[128:131], v1, s[56:59], s77 offen offset:3072 sc1
v_mfma_f32_32x32x16_bf16 v[56:71], v[156:159], v[108:111], v[56:71]
v_add_u32 v95, v95, v93
v_add_u32 v88, s73, v95
v_xor_b32 v89, 16, v88
.p2align 3
s_waitcnt vmcnt(9)
s_nop 0
v_mfma_f32_32x32x16_bf16 v[8:23], v[160:163], v[216:219], v[8:23]
s_add_u32 s77, s77, 4096
s_cmp_ge_u32 s77, s101
s_cselect_b32 s77, 0, s77
buffer_load_dwordx4 v[236:239], v1, s[56:59], s77 offen offset:0 sc1
v_mfma_f32_32x32x16_bf16 v[24:39], v[164:167], v[216:219], v[24:39]
v_xor_b32 v90, 128, v88
v_xor_b32 v91, 144, v88
v_and_b32 v93, 8, v0
.p2align 3
s_waitcnt vmcnt(9)
s_nop 0
v_mfma_f32_32x32x16_bf16 v[40:55], v[160:163], v[112:115], v[40:55]
buffer_load_dwordx4 v[132:135], v1, s[56:59], s77 offen offset:1024 sc1
v_mfma_f32_32x32x16_bf16 v[56:71], v[164:167], v[112:115], v[56:71]
v_cmp_ne_u32 s[74:75], 0, v93
s_lshl_b32 s72, s27, 9
s_add_u32 s72, s72, 160768
.p2align 3
s_waitcnt vmcnt(9)
s_nop 0
v_mfma_f32_32x32x16_bf16 v[8:23], v[168:171], v[220:223], v[8:23]
buffer_load_dwordx4 v[240:243], v1, s[56:59], s77 offen offset:2048 sc1
v_mfma_f32_32x32x16_bf16 v[24:39], v[172:175], v[220:223], v[24:39]
v_lshlrev_b32 v103, 3, v0
v_add_u32 v103, s72, v103
.p2align 3
s_waitcnt vmcnt(9)
s_nop 0
v_mfma_f32_32x32x16_bf16 v[40:55], v[168:171], v[116:119], v[40:55]
buffer_load_dwordx4 v[136:139], v1, s[56:59], s77 offen offset:3072 sc1
v_mfma_f32_32x32x16_bf16 v[56:71], v[172:175], v[116:119], v[56:71]
s_waitcnt vmcnt(9)
s_nop 0
v_mfma_f32_32x32x16_bf16 v[8:23], v[176:179], v[224:227], v[8:23]
s_add_u32 s77, s77, 4096
s_cmp_ge_u32 s77, s101
s_cselect_b32 s77, 0, s77
buffer_load_dwordx4 v[244:247], v1, s[56:59], s77 offen offset:0 sc1
v_mfma_f32_32x32x16_bf16 v[24:39], v[180:183], v[224:227], v[24:39]
s_waitcnt vmcnt(9)
s_nop 0
v_mfma_f32_32x32x16_bf16 v[40:55], v[176:179], v[120:123], v[40:55]
buffer_load_dwordx4 v[140:143], v1, s[56:59], s77 offen offset:1024 sc1
v_mfma_f32_32x32x16_bf16 v[56:71], v[180:183], v[120:123], v[56:71]
v_add_u32 v2, 0x8000, v2
v_add_u32 v3, 0x8000, v3
s_waitcnt vmcnt(9)
s_nop 0
v_mfma_f32_32x32x16_bf16 v[8:23], v[184:187], v[228:231], v[8:23]
buffer_load_dwordx4 v[248:251], v1, s[56:59], s77 offen offset:2048 sc1
v_mfma_f32_32x32x16_bf16 v[24:39], v[188:191], v[228:231], v[24:39]
s_waitcnt vmcnt(9)
s_nop 0
v_mfma_f32_32x32x16_bf16 v[40:55], v[184:187], v[124:127], v[40:55]
ds_read_b64_tr_b16 v[184:185], v2 offset:16384
ds_read_b64_tr_b16 v[186:187], v2 offset:16896
buffer_load_dwordx4 v[144:147], v1, s[56:59], s77 offen offset:3072 sc1
v_mfma_f32_32x32x16_bf16 v[56:71], v[188:191], v[124:127], v[56:71]
ds_read_b64_tr_b16 v[188:189], v3 offset:16384
ds_read_b64_tr_b16 v[190:191], v3 offset:16896
s_waitcnt vmcnt(9)
s_nop 0
v_mfma_f32_32x32x16_bf16 v[8:23], v[192:195], v[232:235], v[8:23]
s_add_u32 s77, s77, 4096
s_cmp_ge_u32 s77, s101
s_cselect_b32 s77, 0, s77
buffer_load_dwordx4 v[104:107], v1, s[56:59], s77 offen offset:0 sc1
v_mfma_f32_32x32x16_bf16 v[24:39], v[196:199], v[232:235], v[24:39]
s_waitcnt vmcnt(9)
s_nop 0
v_mfma_f32_32x32x16_bf16 v[40:55], v[192:195], v[128:131], v[40:55]
ds_read_b64_tr_b16 v[192:193], v2 offset:18432
ds_read_b64_tr_b16 v[194:195], v2 offset:18944
buffer_load_dwordx4 v[148:151], v1, s[56:59], s77 offen offset:1024 sc1
v_mfma_f32_32x32x16_bf16 v[56:71], v[196:199], v[128:131], v[56:71]
ds_read_b64_tr_b16 v[196:197], v3 offset:18432
ds_read_b64_tr_b16 v[198:199], v3 offset:18944
s_waitcnt vmcnt(9)
s_nop 0
v_mfma_f32_32x32x16_bf16 v[8:23], v[200:203], v[236:239], v[8:23]
buffer_load_dwordx4 v[252:255], v1, s[56:59], s77 offen offset:2048 sc1
v_mfma_f32_32x32x16_bf16 v[24:39], v[204:207], v[236:239], v[24:39]
s_waitcnt vmcnt(9)
s_nop 0
v_mfma_f32_32x32x16_bf16 v[40:55], v[200:203], v[132:135], v[40:55]
ds_read_b64_tr_b16 v[200:201], v2 offset:0
ds_read_b64_tr_b16 v[202:203], v2 offset:512
buffer_load_dwordx4 v[152:155], v1, s[56:59], s77 offen offset:3072 sc1
v_mfma_f32_32x32x16_bf16 v[56:71], v[204:207], v[132:135], v[56:71]
ds_read_b64_tr_b16 v[204:205], v3 offset:0
ds_read_b64_tr_b16 v[206:207], v3 offset:512
s_waitcnt vmcnt(9)
s_nop 0
v_mfma_f32_32x32x16_bf16 v[8:23], v[208:211], v[240:243], v[8:23]
s_add_u32 s77, s77, 4096
s_cmp_ge_u32 s77, s101
s_cselect_b32 s77, 0, s77
buffer_load_dwordx4 v[108:111], v1, s[56:59], s77 offen offset:0 sc1
v_mfma_f32_32x32x16_bf16 v[24:39], v[212:215], v[240:243], v[24:39]
s_waitcnt vmcnt(9)
s_nop 0
v_mfma_f32_32x32x16_bf16 v[40:55], v[208:211], v[136:139], v[40:55]
ds_read_b64_tr_b16 v[208:209], v2 offset:2048
ds_read_b64_tr_b16 v[210:211], v2 offset:2560
buffer_load_dwordx4 v[156:159], v1, s[56:59], s77 offen offset:1024 sc1
v_mfma_f32_32x32x16_bf16 v[56:71], v[212:215], v[136:139], v[56:71]
ds_read_b64_tr_b16 v[212:213], v3 offset:2048
ds_read_b64_tr_b16 v[214:215], v3 offset:2560
v_add_u32 v2, 0xffff8000, v2
v_add_u32 v3, 0xffff8000, v3
s_waitcnt vmcnt(9) lgkmcnt(12)
s_nop 0
v_mfma_f32_32x32x16_bf16 v[8:23], v[184:187], v[244:247], v[8:23]
buffer_load_dwordx4 v[216:219], v1, s[56:59], s77 offen offset:2048 sc1
v_mfma_f32_32x32x16_bf16 v[24:39], v[188:191], v[244:247], v[24:39]
s_waitcnt vmcnt(9)
s_nop 0
v_mfma_f32_32x32x16_bf16 v[40:55], v[184:187], v[140:143], v[40:55]
ds_read_b64_tr_b16 v[184:185], v2 offset:16384
ds_read_b64_tr_b16 v[186:187], v2 offset:16896
buffer_load_dwordx4 v[160:163], v1, s[56:59], s77 offen offset:3072 sc1
v_mfma_f32_32x32x16_bf16 v[56:71], v[188:191], v[140:143], v[56:71]
ds_read_b64_tr_b16 v[188:189], v3 offset:16384
ds_read_b64_tr_b16 v[190:191], v3 offset:16896
s_waitcnt vmcnt(9) lgkmcnt(12)
s_nop 0
v_mfma_f32_32x32x16_bf16 v[8:23], v[192:195], v[248:251], v[8:23]
s_add_u32 s77, s77, 4096
s_cmp_ge_u32 s77, s101
s_cselect_b32 s77, 0, s77
buffer_load_dwordx4 v[112:115], v1, s[56:59], s77 offen offset:0 sc1
v_mfma_f32_32x32x16_bf16 v[24:39], v[196:199], v[248:251], v[24:39]
s_waitcnt vmcnt(9)
s_nop 0
v_mfma_f32_32x32x16_bf16 v[40:55], v[192:195], v[144:147], v[40:55]
ds_read_b64_tr_b16 v[192:193], v2 offset:18432
ds_read_b64_tr_b16 v[194:195], v2 offset:18944
buffer_load_dwordx4 v[164:167], v1, s[56:59], s77 offen offset:1024 sc1
v_mfma_f32_32x32x16_bf16 v[56:71], v[196:199], v[144:147], v[56:71]
ds_read_b64_tr_b16 v[196:197], v3 offset:18432
ds_read_b64_tr_b16 v[198:199], v3 offset:18944
s_waitcnt vmcnt(9) lgkmcnt(12)
s_nop 0
v_mfma_f32_32x32x16_bf16 v[8:23], v[200:203], v[104:107], v[8:23]
buffer_load_dwordx4 v[220:223], v1, s[56:59], s77 offen offset:2048 sc1
v_mfma_f32_32x32x16_bf16 v[24:39], v[204:207], v[104:107], v[24:39]
s_waitcnt vmcnt(9)
s_nop 0
v_mfma_f32_32x32x16_bf16 v[40:55], v[200:203], v[148:151], v[40:55]
ds_read_b64_tr_b16 v[200:201], v2 offset:0
ds_read_b64_tr_b16 v[202:203], v2 offset:512
buffer_load_dwordx4 v[168:171], v1, s[56:59], s77 offen offset:3072 sc1
v_mfma_f32_32x32x16_bf16 v[56:71], v[204:207], v[148:151], v[56:71]
ds_read_b64_tr_b16 v[204:205], v3 offset:0
ds_read_b64_tr_b16 v[206:207], v3 offset:512
s_waitcnt vmcnt(9) lgkmcnt(12)
s_nop 0
v_mfma_f32_32x32x16_bf16 v[8:23], v[208:211], v[252:255], v[8:23]
buffer_load_dwordx4 v[72:75], v7, s[44:47], s69 offen offset:0 sc1
v_mfma_f32_32x32x16_bf16 v[24:39], v[212:215], v[252:255], v[24:39]
s_waitcnt vmcnt(9)
s_nop 0
v_mfma_f32_32x32x16_bf16 v[40:55], v[208:211], v[152:155], v[40:55]
ds_read_b64_tr_b16 v[208:209], v2 offset:2048
ds_read_b64_tr_b16 v[210:211], v2 offset:2560
buffer_load_dwordx4 v[76:79], v7, s[44:47], s69 offen offset:64 sc1
v_mfma_f32_32x32x16_bf16 v[56:71], v[212:215], v[152:155], v[56:71]
ds_read_b64_tr_b16 v[212:213], v3 offset:2048
ds_read_b64_tr_b16 v[214:215], v3 offset:2560
v_add_u32 v2, 0x18000, v2
v_add_u32 v3, 0x18000, v3
s_waitcnt vmcnt(9) lgkmcnt(12)
s_nop 0
v_mfma_f32_32x32x16_bf16 v[8:23], v[184:187], v[108:111], v[8:23]
s_add_u32 s77, s77, 4096
s_cmp_ge_u32 s77, s101
s_cselect_b32 s77, 0, s77
buffer_load_dwordx4 v[116:119], v1, s[56:59], s77 offen offset:0 sc1
v_mfma_f32_32x32x16_bf16 v[24:39], v[188:191], v[108:111], v[24:39]
s_waitcnt vmcnt(9)
s_nop 0
v_mfma_f32_32x32x16_bf16 v[40:55], v[184:187], v[156:159], v[40:55]
ds_read_b64_tr_b16 v[184:185], v2 offset:49152
ds_read_b64_tr_b16 v[186:187], v2 offset:49664
buffer_load_dwordx4 v[172:175], v1, s[56:59], s77 offen offset:1024 sc1
v_mfma_f32_32x32x16_bf16 v[56:71], v[188:191], v[156:159], v[56:71]
ds_read_b64_tr_b16 v[188:189], v3 offset:49152
ds_read_b64_tr_b16 v[190:191], v3 offset:49664
s_waitcnt vmcnt(9) lgkmcnt(12)
s_nop 0
v_mfma_f32_32x32x16_bf16 v[8:23], v[192:195], v[216:219], v[8:23]
buffer_load_dwordx4 v[224:227], v1, s[56:59], s77 offen offset:2048 sc1
v_mfma_f32_32x32x16_bf16 v[24:39], v[196:199], v[216:219], v[24:39]
s_waitcnt vmcnt(9)
s_nop 0
v_mfma_f32_32x32x16_bf16 v[40:55], v[192:195], v[160:163], v[40:55]
ds_read_b64_tr_b16 v[192:193], v2 offset:51200
ds_read_b64_tr_b16 v[194:195], v2 offset:51712
buffer_load_dwordx4 v[176:179], v1, s[56:59], s77 offen offset:3072 sc1
v_mfma_f32_32x32x16_bf16 v[56:71], v[196:199], v[160:163], v[56:71]
ds_read_b64_tr_b16 v[196:197], v3 offset:51200
ds_read_b64_tr_b16 v[198:199], v3 offset:51712
s_waitcnt vmcnt(9) lgkmcnt(12)
s_nop 0
v_mfma_f32_32x32x16_bf16 v[8:23], v[200:203], v[112:115], v[8:23]
s_add_u32 s77, s77, 4096
s_cmp_ge_u32 s77, s101
s_cselect_b32 s77, 0, s77
buffer_load_dwordx4 v[120:123], v1, s[56:59], s77 offen offset:0 sc1
v_mfma_f32_32x32x16_bf16 v[24:39], v[204:207], v[112:115], v[24:39]
s_waitcnt vmcnt(9)
s_nop 0
v_mfma_f32_32x32x16_bf16 v[40:55], v[200:203], v[164:167], v[40:55]
ds_read_b64_tr_b16 v[200:201], v2 offset:32768
ds_read_b64_tr_b16 v[202:203], v2 offset:33280
buffer_load_dwordx4 v[180:183], v1, s[56:59], s77 offen offset:1024 sc1
v_mfma_f32_32x32x16_bf16 v[56:71], v[204:207], v[164:167], v[56:71]
ds_read_b64_tr_b16 v[204:205], v3 offset:32768
ds_read_b64_tr_b16 v[206:207], v3 offset:33280
s_waitcnt vmcnt(9) lgkmcnt(12)
s_nop 0
v_mfma_f32_32x32x16_bf16 v[8:23], v[208:211], v[220:223], v[8:23]
buffer_load_dwordx4 v[228:231], v1, s[56:59], s77 offen offset:2048 sc1
v_mfma_f32_32x32x16_bf16 v[24:39], v[212:215], v[220:223], v[24:39]
s_waitcnt vmcnt(9)
s_nop 0
v_mfma_f32_32x32x16_bf16 v[40:55], v[208:211], v[168:171], v[40:55]
ds_read_b64_tr_b16 v[208:209], v2 offset:34816
ds_read_b64_tr_b16 v[210:211], v2 offset:35328
buffer_load_dwordx4 v[124:127], v1, s[56:59], s77 offen offset:3072 sc1
v_mfma_f32_32x32x16_bf16 v[56:71], v[212:215], v[168:171], v[56:71]
ds_read_b64_tr_b16 v[212:213], v3 offset:34816
ds_read_b64_tr_b16 v[214:215], v3 offset:35328
s_waitcnt vmcnt(7) lgkmcnt(12)
s_nop 0
v_mfma_f32_32x32x16_bf16 v[8:23], v[184:187], v[116:119], v[8:23]
s_add_u32 s77, s77, 4096
s_cmp_ge_u32 s77, s101
s_cselect_b32 s77, 0, s77
buffer_load_dwordx4 v[232:235], v1, s[56:59], s77 offen offset:0 sc1
v_mfma_f32_32x32x16_bf16 v[24:39], v[188:191], v[116:119], v[24:39]
buffer_load_dwordx4 v[128:131], v1, s[56:59], s77 offen offset:1024 sc1
s_waitcnt vmcnt(8)
s_nop 0
v_mfma_f32_32x32x16_bf16 v[40:55], v[184:187], v[172:175], v[40:55]
ds_read_b64_tr_b16 v[184:185], v2 offset:16384
ds_read_b64_tr_b16 v[186:187], v2 offset:16896
buffer_load_dwordx4 v[236:239], v1, s[56:59], s77 offen offset:2048 sc1
v_mfma_f32_32x32x16_bf16 v[56:71], v[188:191], v[172:175], v[56:71]
ds_read_b64_tr_b16 v[188:189], v3 offset:16384
ds_read_b64_tr_b16 v[190:191], v3 offset:16896
buffer_load_dwordx4 v[132:135], v1, s[56:59], s77 offen offset:3072 sc1
s_waitcnt vmcnt(9) lgkmcnt(12)
s_nop 0
v_mfma_f32_32x32x16_bf16 v[8:23], v[192:195], v[224:227], v[8:23]
s_add_u32 s77, s77, 4096
s_cmp_ge_u32 s77, s101
s_cselect_b32 s77, 0, s77
buffer_load_dwordx4 v[240:243], v1, s[56:59], s77 offen offset:0 sc1
v_mfma_f32_32x32x16_bf16 v[24:39], v[196:199], v[224:227], v[24:39]
s_waitcnt vmcnt(9)
s_nop 0
v_mfma_f32_32x32x16_bf16 v[40:55], v[192:195], v[176:179], v[40:55]
ds_read_b64_tr_b16 v[192:193], v2 offset:18432
ds_read_b64_tr_b16 v[194:195], v2 offset:18944
buffer_load_dwordx4 v[136:139], v1, s[56:59], s77 offen offset:1024 sc1
v_mfma_f32_32x32x16_bf16 v[56:71], v[196:199], v[176:179], v[56:71]
ds_read_b64_tr_b16 v[196:197], v3 offset:18432
ds_read_b64_tr_b16 v[198:199], v3 offset:18944
s_waitcnt vmcnt(9) lgkmcnt(12)
s_nop 0
v_mfma_f32_32x32x16_bf16 v[8:23], v[200:203], v[120:123], v[8:23]
buffer_load_dwordx4 v[244:247], v1, s[56:59], s77 offen offset:2048 sc1
v_mfma_f32_32x32x16_bf16 v[24:39], v[204:207], v[120:123], v[24:39]
s_waitcnt vmcnt(9)
s_nop 0
v_mfma_f32_32x32x16_bf16 v[40:55], v[200:203], v[180:183], v[40:55]
ds_read_b64_tr_b16 v[200:201], v2 offset:0
ds_read_b64_tr_b16 v[202:203], v2 offset:512
buffer_load_dwordx4 v[140:143], v1, s[56:59], s77 offen offset:3072 sc1
v_mfma_f32_32x32x16_bf16 v[56:71], v[204:207], v[180:183], v[56:71]
ds_read_b64_tr_b16 v[204:205], v3 offset:0
ds_read_b64_tr_b16 v[206:207], v3 offset:512
s_waitcnt vmcnt(9) lgkmcnt(12)
s_nop 0
v_mfma_f32_32x32x16_bf16 v[8:23], v[208:211], v[228:231], v[8:23]
s_add_u32 s77, s77, 4096
s_cmp_ge_u32 s77, s101
s_cselect_b32 s77, 0, s77
buffer_load_dwordx4 v[248:251], v1, s[56:59], s77 offen offset:0 sc1
v_mfma_f32_32x32x16_bf16 v[24:39], v[212:215], v[228:231], v[24:39]
s_waitcnt vmcnt(9)
s_nop 0
v_mfma_f32_32x32x16_bf16 v[40:55], v[208:211], v[124:127], v[40:55]
ds_read_b64_tr_b16 v[208:209], v2 offset:2048
ds_read_b64_tr_b16 v[210:211], v2 offset:2560
buffer_load_dwordx4 v[144:147], v1, s[56:59], s77 offen offset:1024 sc1
v_mfma_f32_32x32x16_bf16 v[56:71], v[212:215], v[124:127], v[56:71]
ds_read_b64_tr_b16 v[212:213], v3 offset:2048
ds_read_b64_tr_b16 v[214:215], v3 offset:2560
v_add_u32 v2, 0xffff0000, v2
v_add_u32 v3, 0xffff0000, v3
s_waitcnt vmcnt(9) lgkmcnt(12)
s_nop 0
v_mfma_f32_32x32x16_bf16 v[8:23], v[184:187], v[232:235], v[8:23]
buffer_load_dwordx4 v[104:107], v1, s[56:59], s77 offen offset:2048 sc1
v_mfma_f32_32x32x16_bf16 v[24:39], v[188:191], v[232:235], v[24:39]
s_waitcnt vmcnt(9)
s_nop 0
v_mfma_f32_32x32x16_bf16 v[40:55], v[184:187], v[128:131], v[40:55]
ds_read_b64_tr_b16 v[184:185], v2 offset:49152
ds_read_b64_tr_b16 v[186:187], v2 offset:49664
buffer_load_dwordx4 v[148:151], v1, s[56:59], s77 offen offset:3072 sc1
v_mfma_f32_32x32x16_bf16 v[56:71], v[188:191], v[128:131], v[56:71]
ds_read_b64_tr_b16 v[188:189], v3 offset:49152
ds_read_b64_tr_b16 v[190:191], v3 offset:49664
s_waitcnt vmcnt(9) lgkmcnt(12)
s_nop 0
v_mfma_f32_32x32x16_bf16 v[8:23], v[192:195], v[236:239], v[8:23]
v_mfma_f32_32x32x16_bf16 v[24:39], v[196:199], v[236:239], v[24:39]
s_waitcnt vmcnt(8)
s_nop 0
v_mfma_f32_32x32x16_bf16 v[40:55], v[192:195], v[132:135], v[40:55]
ds_read_b64_tr_b16 v[192:193], v2 offset:51200
ds_read_b64_tr_b16 v[194:195], v2 offset:51712
v_mfma_f32_32x32x16_bf16 v[56:71], v[196:199], v[132:135], v[56:71]
ds_read_b64_tr_b16 v[196:197], v3 offset:51200
ds_read_b64_tr_b16 v[198:199], v3 offset:51712
s_waitcnt vmcnt(7) lgkmcnt(12)
s_nop 0
v_mfma_f32_32x32x16_bf16 v[8:23], v[200:203], v[240:243], v[8:23]
v_mfma_f32_32x32x16_bf16 v[24:39], v[204:207], v[240:243], v[24:39]
s_waitcnt vmcnt(6)
s_nop 0
v_mfma_f32_32x32x16_bf16 v[40:55], v[200:203], v[136:139], v[40:55]
v_mfma_f32_32x32x16_bf16 v[56:71], v[204:207], v[136:139], v[56:71]
s_waitcnt vmcnt(5) lgkmcnt(8)
s_nop 0
v_mfma_f32_32x32x16_bf16 v[8:23], v[208:211], v[244:247], v[8:23]
v_mfma_f32_32x32x16_bf16 v[24:39], v[212:215], v[244:247], v[24:39]
s_waitcnt vmcnt(4)
s_nop 0
v_mfma_f32_32x32x16_bf16 v[40:55], v[208:211], v[140:143], v[40:55]
v_mfma_f32_32x32x16_bf16 v[56:71], v[212:215], v[140:143], v[56:71]
s_waitcnt vmcnt(0) lgkmcnt(0)
s_nop 0
v_mfma_f32_32x32x16_bf16 v[8:23], v[184:187], v[248:251], v[8:23]
v_mfma_f32_32x32x16_bf16 v[8:23], v[192:195], v[104:107], v[8:23]
v_mfma_f32_32x32x16_bf16 v[24:39], v[188:191], v[248:251], v[24:39]
v_cndmask_b32 v96, v72, v73, s[74:75]
v_cndmask_b32 v98, v76, v77, s[74:75]
v_sub_f32 v100, 1.0, v96
v_sub_f32 v101, 1.0, v98
v_cvt_pk_bf16_f32 v100, v100, v101
v_mfma_f32_32x32x16_bf16 v[24:39], v[196:199], v[104:107], v[24:39]
v_and_b32 v102, 0xffff0000, v100
v_lshlrev_b32 v100, 16, v100
v_cmp_eq_u64 vcc, s[30:31], v[74:75]
v_cmp_eq_u64 s[64:65], s[30:31], v[78:79]
v_mfma_f32_32x32x16_bf16 v[40:55], v[184:187], v[144:147], v[40:55]
ds_write_b128 v80, v[8:11] offset:32768
ds_write_b128 v81, v[12:15] offset:32768
ds_write_b128 v82, v[16:19] offset:32768
ds_write_b128 v83, v[20:23] offset:32768
v_mfma_f32_32x32x16_bf16 v[40:55], v[192:195], v[148:151], v[40:55]
s_nop 1
ds_write_b128 v84, v[24:27] offset:32768
ds_write_b128 v85, v[28:31] offset:32768
v_mfma_f32_32x32x16_bf16 v[56:71], v[188:191], v[144:147], v[56:71]
ds_write_b128 v86, v[32:35] offset:32768
ds_write_b128 v87, v[36:39] offset:32768
v_mfma_f32_32x32x16_bf16 v[56:71], v[196:199], v[148:151], v[56:71]
s_nop 3
ds_write_b128 v80, v[40:43] offset:0
ds_write_b128 v81, v[44:47] offset:0
ds_write_b128 v82, v[48:51] offset:0
ds_write_b128 v83, v[52:55] offset:0
s_nop 3
ds_write_b128 v84, v[56:59] offset:0
ds_write_b128 v85, v[60:63] offset:0
ds_write_b128 v86, v[64:67] offset:0
ds_write_b128 v87, v[68:71] offset:0
s_branch KL_FIN
.p2align 3
KL_V16:
buffer_load_dwordx4 v[216:219], v1, s[56:59], s77 offen offset:0 sc1
buffer_load_dwordx4 v[220:223], v1, s[56:59], s77 offen offset:1024 sc1
buffer_load_dwordx4 v[224:227], v1, s[56:59], s77 offen offset:2048 sc1
buffer_load_dwordx4 v[228:231], v1, s[56:59], s77 offen offset:3072 sc1
s_add_u32 s77, s77, 4096
s_cmp_ge_u32 s77, s101
s_cselect_b32 s77, 0, s77
buffer_load_dwordx4 v[232:235], v1, s[56:59], s77 offen offset:0 sc1
buffer_load_dwordx4 v[236:239], v1, s[56:59], s77 offen offset:1024 sc1
buffer_load_dwordx4 v[240:243], v1, s[56:59], s77 offen offset:2048 sc1
buffer_load_dwordx4 v[244:247], v1, s[56:59], s77 offen offset:3072 sc1
s_add_u32 s77, s77, 4096
s_cmp_ge_u32 s77, s101
s_cselect_b32 s77, 0, s77
buffer_load_dwordx4 v[248:251], v1, s[56:59], s77 offen offset:0 sc1
buffer_load_dwordx4 v[252:255], v1, s[56:59], s77 offen offset:1024 sc1
s_waitcnt vmcnt(9)
s_nop 0
v_mfma_f32_32x32x16_bf16 v[8:23], v[72:75], v[216:219], 0
v_mfma_f32_32x32x16_bf16 v[24:39], v[76:79], v[216:219], 0
buffer_load_dwordx4 v[216:219], v1, s[56:59], s77 offen offset:2048 sc1
s_waitcnt vmcnt(9)
s_nop 0
v_mfma_f32_32x32x16_bf16 v[40:55], v[72:75], v[220:223], 0
v_mfma_f32_32x32x16_bf16 v[56:71], v[76:79], v[220:223], 0
buffer_load_dwordx4 v[220:223], v1, s[56:59], s77 offen offset:3072 sc1
s_waitcnt vmcnt(9)
s_nop 0
v_mfma_f32_32x32x16_bf16 v[8:23], v[80:83], v[224:227], v[8:23]
v_mfma_f32_32x32x16_bf16 v[24:39], v[84:87], v[224:227], v[24:39]
s_add_u32 s77, s77, 4096
s_cmp_ge_u32 s77, s101
s_cselect_b32 s77, 0, s77
buffer_load_dwordx4 v[224:227], v1, s[56:59], s77 offen offset:0 sc1
s_waitcnt vmcnt(9)
s_nop 0
v_mfma_f32_32x32x16_bf16 v[40:55], v[80:83], v[228:231], v[40:55]
v_mfma_f32_32x32x16_bf16 v[56:71], v[84:87], v[228:231], v[56:71]
buffer_load_dwordx4 v[228:231], v1, s[56:59], s77 offen offset:1024 sc1
s_waitcnt vmcnt(9)
s_nop 0
v_mfma_f32_32x32x16_bf16 v[8:23], v[88:91], v[232:235], v[8:23]
v_mfma_f32_32x32x16_bf16 v[24:39], v[92:95], v[232:235], v[24:39]
buffer_load_dwordx4 v[232:235], v1, s[56:59], s77 offen offset:2048 sc1
s_waitcnt vmcnt(9)
s_nop 0
v_mfma_f32_32x32x16_bf16 v[40:55], v[88:91], v[236:239], v[40:55]
v_mfma_f32_32x32x16_bf16 v[56:71], v[92:95], v[236:239], v[56:71]
buffer_load_dwordx4 v[236:239], v1, s[56:59], s77 offen offset:3072 sc1
s_waitcnt vmcnt(9)
s_nop 0
v_mfma_f32_32x32x16_bf16 v[8:23], v[96:99], v[240:243], v[8:23]
v_mfma_f32_32x32x16_bf16 v[24:39], v[100:103], v[240:243], v[24:39]
s_add_u32 s77, s77, 4096
s_cmp_ge_u32 s77, s101
s_cselect_b32 s77, 0, s77
buffer_load_dwordx4 v[240:243], v1, s[56:59], s77 offen offset:0 sc1
s_waitcnt vmcnt(9)
s_nop 0
v_mfma_f32_32x32x16_bf16 v[40:55], v[96:99], v[244:247], v[40:55]
v_mfma_f32_32x32x16_bf16 v[56:71], v[100:103], v[244:247], v[56:71]
buffer_load_dwordx4 v[244:247], v1, s[56:59], s77 offen offset:1024 sc1
s_waitcnt vmcnt(9)
s_nop 0
v_mfma_f32_32x32x16_bf16 v[8:23], v[104:107], v[248:251], v[8:23]
s_lshr_b32 s64, s28, 1
s_lshl_b32 s64, s64, 7
s_lshl_b32 s65, s27, 5
.p2align 3
v_mfma_f32_32x32x16_bf16 v[24:39], v[108:111], v[248:251], v[24:39]
buffer_load_dwordx4 v[248:251], v1, s[56:59], s77 offen offset:2048 sc1
s_waitcnt vmcnt(9)
s_nop 0
v_mfma_f32_32x32x16_bf16 v[40:55], v[104:107], v[252:255], v[40:55]
buffer_load_dwordx4 v[104:107], v1, s[56:59], s77 offen offset:3072 sc1
v_mfma_f32_32x32x16_bf16 v[56:71], v[108:111], v[252:255], v[56:71]
s_add_u32 s64, s64, s65
s_and_b32 s65, s28, 1
s_add_u32 s64, s64, s65
.p2align 3
s_waitcnt vmcnt(9)
s_nop 0
v_mfma_f32_32x32x16_bf16 v[8:23], v[112:115], v[216:219], v[8:23]
s_add_u32 s77, s77, 4096
s_cmp_ge_u32 s77, s101
s_cselect_b32 s77, 0, s77
buffer_load_dwordx4 v[252:255], v1, s[56:59], s77 offen offset:0 sc1
v_mfma_f32_32x32x16_bf16 v[24:39], v[116:119], v[216:219], v[24:39]
s_lshl_b32 s64, s64, 10
s_lshl_b32 s65, s29, 7
s_add_u32 s70, s64, s65
.p2align 3
s_waitcnt vmcnt(9)
s_nop 0
v_mfma_f32_32x32x16_bf16 v[40:55], v[112:115], v[220:223], v[40:55]
buffer_load_dwordx4 v[108:111], v1, s[56:59], s77 offen offset:1024 sc1
v_mfma_f32_32x32x16_bf16 v[56:71], v[116:119], v[220:223], v[56:71]
s_add_u32 s71, s70, 16384
s_sub_u32 s72, s79, 32768
s_lshl_b32 s73, s27, 14
.p2align 3
s_waitcnt vmcnt(9)
s_nop 0
v_mfma_f32_32x32x16_bf16 v[8:23], v[120:123], v[224:227], v[8:23]
buffer_load_dwordx4 v[216:219], v1, s[56:59], s77 offen offset:2048 sc1
v_mfma_f32_32x32x16_bf16 v[24:39], v[124:127], v[224:227], v[24:39]
s_sub_u32 s73, 131072, s73
v_and_b32 v93, 15, v0
v_lshrrev_b32 v94, 5, v0
.p2align 3
s_waitcnt vmcnt(9)
s_nop 0
v_mfma_f32_32x32x16_bf16 v[40:55], v[120:123], v[228:231], v[40:55]
buffer_load_dwordx4 v[112:115], v1, s[56:59], s77 offen offset:3072 sc1
v_mfma_f32_32x32x16_bf16 v[56:71], v[124:127], v[228:231], v[56:71]
v_xor_b32 v94, v94, v93
v_lshlrev_b32 v94, 4, v94
v_lshlrev_b32 v95, 8, v93
.p2align 3
s_waitcnt vmcnt(9)
s_nop 0
v_mfma_f32_32x32x16_bf16 v[8:23], v[128:131], v[232:235], v[8:23]
s_add_u32 s77, s77, 4096
s_cmp_ge_u32 s77, s101
s_cselect_b32 s77, 0, s77
buffer_load_dwordx4 v[220:223], v1, s[56:59], s77 offen offset:0 sc1
v_mfma_f32_32x32x16_bf16 v[24:39], v[132:135], v[232:235], v[24:39]
v_add_u32 v94, v94, v95
v_bfe_u32 v95, v0, 4, 1
v_lshlrev_b32 v95, 14, v95
.p2align 3
s_waitcnt vmcnt(9)
s_nop 0
v_mfma_f32_32x32x16_bf16 v[40:55], v[128:131], v[236:239], v[40:55]
buffer_load_dwordx4 v[116:119], v1, s[56:59], s77 offen offset:1024 sc1
v_mfma_f32_32x32x16_bf16 v[56:71], v[132:135], v[236:239], v[56:71]
v_sub_u32 v94, v94, v95
v_add_u32 v80, s72, v94
v_xor_b32 v81, 32, v80
.p2align 3
s_waitcnt vmcnt(9)
s_nop 0
v_mfma_f32_32x32x16_bf16 v[8:23], v[136:139], v[240:243], v[8:23]
buffer_load_dwordx4 v[224:227], v1, s[56:59], s77 offen offset:2048 sc1
v_mfma_f32_32x32x16_bf16 v[24:39], v[140:143], v[240:243], v[24:39]
v_xor_b32 v82, 64, v80
v_xor_b32 v83, 96, v80
v_xor_b32 v84, 128, v80
.p2align 3
s_waitcnt vmcnt(9)
s_nop 0
v_mfma_f32_32x32x16_bf16 v[40:55], v[136:139], v[244:247], v[40:55]
buffer_load_dwordx4 v[120:123], v1, s[56:59], s77 offen offset:3072 sc1
v_mfma_f32_32x32x16_bf16 v[56:71], v[140:143], v[244:247], v[56:71]
v_xor_b32 v85, 160, v80
v_xor_b32 v86, 192, v80
v_xor_b32 v87, 224, v80
.p2align 3
s_waitcnt vmcnt(9)
s_nop 0
v_mfma_f32_32x32x16_bf16 v[8:23], v[144:147], v[248:251], v[8:23]
s_add_u32 s77, s77, 4096
s_cmp_ge_u32 s77, s101
s_cselect_b32 s77, 0, s77
buffer_load_dwordx4 v[228:231], v1, s[56:59], s77 offen offset:0 sc1
v_mfma_f32_32x32x16_bf16 v[24:39], v[148:151], v[248:251], v[24:39]
v_lshrrev_b32 v93, 3, v0
v_and_b32 v94, 7, v0
v_lshlrev_b32 v92, 11, v93
.p2align 3
s_waitcnt vmcnt(9)
s_nop 0
v_mfma_f32_32x32x16_bf16 v[40:55], v[144:147], v[104:107], v[40:55]
buffer_load_dwordx4 v[124:127], v1, s[56:59], s77 offen offset:1024 sc1
v_mfma_f32_32x32x16_bf16 v[56:71], v[148:151], v[104:107], v[56:71]
v_lshlrev_b32 v95, 4, v94
v_add_u32 v92, v92, v95
v_lshlrev_b32 v95, 1, v94
.p2align 3
s_waitcnt vmcnt(9)
s_nop 0
v_mfma_f32_32x32x16_bf16 v[8:23], v[152:155], v[252:255], v[8:23]
buffer_load_dwordx4 v[232:235], v1, s[56:59], s77 offen offset:2048 sc1
v_mfma_f32_32x32x16_bf16 v[24:39], v[156:159], v[252:255], v[24:39]
v_xor_b32 v95, v95, v93
v_lshlrev_b32 v95, 4, v95
v_lshlrev_b32 v93, 8, v93
.p2align 3
s_waitcnt vmcnt(9)
s_nop 0
v_mfma_f32_32x32x16_bf16 v[40:55], v[152:155], v[108:111], v[40:55]
buffer_load_dwordx4 v[128:131], v1, s[56:59], s77 offen offset:3072 sc1
v_mfma_f32_32x32x16_bf16 v[56:71], v[156:159], v[108:111], v[56:71]
v_add_u32 v95, v95, v93
v_add_u32 v88, s73, v95
v_xor_b32 v89, 16, v88
.p2align 3
s_waitcnt vmcnt(9)
s_nop 0
v_mfma_f32_32x32x16_bf16 v[8:23], v[160:163], v[216:219], v[8:23]
s_add_u32 s77, s77, 4096
s_cmp_ge_u32 s77, s101
s_cselect_b32 s77, 0, s77
buffer_load_dwordx4 v[236:239], v1, s[56:59], s77 offen offset:0 sc1
v_mfma_f32_32x32x16_bf16 v[24:39], v[164:167], v[216:219], v[24:39]
v_xor_b32 v90, 128, v88
v_xor_b32 v91, 144, v88
v_and_b32 v93, 8, v0
.p2align 3
s_waitcnt vmcnt(9)
s_nop 0
v_mfma_f32_32x32x16_bf16 v[40:55], v[160:163], v[112:115], v[40:55]
buffer_load_dwordx4 v[132:135], v1, s[56:59], s77 offen offset:1024 sc1
v_mfma_f32_32x32x16_bf16 v[56:71], v[164:167], v[112:115], v[56:71]
v_cmp_ne_u32 s[74:75], 0, v93
s_lshl_b32 s72, s27, 9
s_add_u32 s72, s72, 160768
.p2align 3
s_waitcnt vmcnt(9)
s_nop 0
v_mfma_f32_32x32x16_bf16 v[8:23], v[168:171], v[220:223], v[8:23]
buffer_load_dwordx4 v[240:243], v1, s[56:59], s77 offen offset:2048 sc1
v_mfma_f32_32x32x16_bf16 v[24:39], v[172:175], v[220:223], v[24:39]
v_lshlrev_b32 v103, 3, v0
v_add_u32 v103, s72, v103
.p2align 3
s_waitcnt vmcnt(9)
s_nop 0
v_mfma_f32_32x32x16_bf16 v[40:55], v[168:171], v[116:119], v[40:55]
buffer_load_dwordx4 v[136:139], v1, s[56:59], s77 offen offset:3072 sc1
v_mfma_f32_32x32x16_bf16 v[56:71], v[172:175], v[116:119], v[56:71]
s_waitcnt vmcnt(9)
s_nop 0
v_mfma_f32_32x32x16_bf16 v[8:23], v[176:179], v[224:227], v[8:23]
s_add_u32 s77, s77, 4096
s_cmp_ge_u32 s77, s101
s_cselect_b32 s77, 0, s77
buffer_load_dwordx4 v[244:247], v1, s[56:59], s77 offen offset:0 sc1
v_mfma_f32_32x32x16_bf16 v[24:39], v[180:183], v[224:227], v[24:39]
s_waitcnt vmcnt(9)
s_nop 0
v_mfma_f32_32x32x16_bf16 v[40:55], v[176:179], v[120:123], v[40:55]
buffer_load_dwordx4 v[140:143], v1, s[56:59], s77 offen offset:1024 sc1
v_mfma_f32_32x32x16_bf16 v[56:71], v[180:183], v[120:123], v[56:71]
v_add_u32 v2, 0x8000, v2
v_add_u32 v3, 0x8000, v3
s_waitcnt vmcnt(9)
s_nop 0
v_mfma_f32_32x32x16_bf16 v[8:23], v[184:187], v[228:231], v[8:23]
buffer_load_dwordx4 v[248:251], v1, s[56:59], s77 offen offset:2048 sc1
v_mfma_f32_32x32x16_bf16 v[24:39], v[188:191], v[228:231], v[24:39]
s_waitcnt vmcnt(9)
s_nop 0
v_mfma_f32_32x32x16_bf16 v[40:55], v[184:187], v[124:127], v[40:55]
ds_read_b64_tr_b16 v[184:185], v2 offset:16384
ds_read_b64_tr_b16 v[186:187], v2 offset:16896
buffer_load_dwordx4 v[144:147], v1, s[56:59], s77 offen offset:3072 sc1
v_mfma_f32_32x32x16_bf16 v[56:71], v[188:191], v[124:127], v[56:71]
ds_read_b64_tr_b16 v[188:189], v3 offset:16384
ds_read_b64_tr_b16 v[190:191], v3 offset:16896
s_waitcnt vmcnt(9)
s_nop 0
v_mfma_f32_32x32x16_bf16 v[8:23], v[192:195], v[232:235], v[8:23]
s_add_u32 s77, s77, 4096
s_cmp_ge_u32 s77, s101
s_cselect_b32 s77, 0, s77
buffer_load_dwordx4 v[104:107], v1, s[56:59], s77 offen offset:0 sc1
v_mfma_f32_32x32x16_bf16 v[24:39], v[196:199], v[232:235], v[24:39]
s_waitcnt vmcnt(9)
s_nop 0
v_mfma_f32_32x32x16_bf16 v[40:55], v[192:195], v[128:131], v[40:55]
ds_read_b64_tr_b16 v[192:193], v2 offset:18432
ds_read_b64_tr_b16 v[194:195], v2 offset:18944
buffer_load_dwordx4 v[148:151], v1, s[56:59], s77 offen offset:1024 sc1
v_mfma_f32_32x32x16_bf16 v[56:71], v[196:199], v[128:131], v[56:71]
ds_read_b64_tr_b16 v[196:197], v3 offset:18432
ds_read_b64_tr_b16 v[198:199], v3 offset:18944
s_waitcnt vmcnt(9)
s_nop 0
v_mfma_f32_32x32x16_bf16 v[8:23], v[200:203], v[236:239], v[8:23]
buffer_load_dwordx4 v[252:255], v1, s[56:59], s77 offen offset:2048 sc1
v_mfma_f32_32x32x16_bf16 v[24:39], v[204:207], v[236:239], v[24:39]
s_waitcnt vmcnt(9)
s_nop 0
v_mfma_f32_32x32x16_bf16 v[40:55], v[200:203], v[132:135], v[40:55]
ds_read_b64_tr_b16 v[200:201], v2 offset:0
ds_read_b64_tr_b16 v[202:203], v2 offset:512
buffer_load_dwordx4 v[152:155], v1, s[56:59], s77 offen offset:3072 sc1
v_mfma_f32_32x32x16_bf16 v[56:71], v[204:207], v[132:135], v[56:71]
ds_read_b64_tr_b16 v[204:205], v3 offset:0
ds_read_b64_tr_b16 v[206:207], v3 offset:512
s_waitcnt vmcnt(9)
s_nop 0
v_mfma_f32_32x32x16_bf16 v[8:23], v[208:211], v[240:243], v[8:23]
s_add_u32 s77, s77, 4096
s_cmp_ge_u32 s77, s101
s_cselect_b32 s77, 0, s77
buffer_load_dwordx4 v[108:111], v1, s[56:59], s77 offen offset:0 sc1
v_mfma_f32_32x32x16_bf16 v[24:39], v[212:215], v[240:243], v[24:39]
s_waitcnt vmcnt(9)
s_nop 0
v_mfma_f32_32x32x16_bf16 v[40:55], v[208:211], v[136:139], v[40:55]
ds_read_b64_tr_b16 v[208:209], v2 offset:2048
ds_read_b64_tr_b16 v[210:211], v2 offset:2560
buffer_load_dwordx4 v[156:159], v1, s[56:59], s77 offen offset:1024 sc1
v_mfma_f32_32x32x16_bf16 v[56:71], v[212:215], v[136:139], v[56:71]
ds_read_b64_tr_b16 v[212:213], v3 offset:2048
ds_read_b64_tr_b16 v[214:215], v3 offset:2560
v_add_u32 v2, 0xffff8000, v2
v_add_u32 v3, 0xffff8000, v3
s_waitcnt vmcnt(9) lgkmcnt(12)
s_nop 0
v_mfma_f32_32x32x16_bf16 v[8:23], v[184:187], v[244:247], v[8:23]
buffer_load_dwordx4 v[216:219], v1, s[56:59], s77 offen offset:2048 sc1
v_mfma_f32_32x32x16_bf16 v[24:39], v[188:191], v[244:247], v[24:39]
s_waitcnt vmcnt(9)
s_nop 0
v_mfma_f32_32x32x16_bf16 v[40:55], v[184:187], v[140:143], v[40:55]
ds_read_b64_tr_b16 v[184:185], v2 offset:16384
ds_read_b64_tr_b16 v[186:187], v2 offset:16896
buffer_load_dwordx4 v[160:163], v1, s[56:59], s77 offen offset:3072 sc1
v_mfma_f32_32x32x16_bf16 v[56:71], v[188:191], v[140:143], v[56:71]
ds_read_b64_tr_b16 v[188:189], v3 offset:16384
ds_read_b64_tr_b16 v[190:191], v3 offset:16896
s_waitcnt vmcnt(9) lgkmcnt(12)
s_nop 0
v_mfma_f32_32x32x16_bf16 v[8:23], v[192:195], v[248:251], v[8:23]
s_add_u32 s77, s77, 4096
s_cmp_ge_u32 s77, s101
s_cselect_b32 s77, 0, s77
buffer_load_dwordx4 v[112:115], v1, s[56:59], s77 offen offset:0 sc1
v_mfma_f32_32x32x16_bf16 v[24:39], v[196:199], v[248:251], v[24:39]
s_waitcnt vmcnt(9)
s_nop 0
v_mfma_f32_32x32x16_bf16 v[40:55], v[192:195], v[144:147], v[40:55]
ds_read_b64_tr_b16 v[192:193], v2 offset:18432
ds_read_b64_tr_b16 v[194:195], v2 offset:18944
buffer_load_dwordx4 v[164:167], v1, s[56:59], s77 offen offset:1024 sc1
v_mfma_f32_32x32x16_bf16 v[56:71], v[196:199], v[144:147], v[56:71]
ds_read_b64_tr_b16 v[196:197], v3 offset:18432
ds_read_b64_tr_b16 v[198:199], v3 offset:18944
v_add_u32 v2, 0x18000, v2
v_add_u32 v3, 0x18000, v3
s_waitcnt vmcnt(9) lgkmcnt(12)
s_nop 0
v_mfma_f32_32x32x16_bf16 v[8:23], v[200:203], v[104:107], v[8:23]
buffer_load_dwordx4 v[220:223], v1, s[56:59], s77 offen offset:2048 sc1
v_mfma_f32_32x32x16_bf16 v[24:39], v[204:207], v[104:107], v[24:39]
s_waitcnt vmcnt(9)
s_nop 0
v_mfma_f32_32x32x16_bf16 v[40:55], v[200:203], v[148:151], v[40:55]
ds_read_b64_tr_b16 v[200:201], v2 offset:49152
ds_read_b64_tr_b16 v[202:203], v2 offset:49664
buffer_load_dwordx4 v[168:171], v1, s[56:59], s77 offen offset:3072 sc1
v_mfma_f32_32x32x16_bf16 v[56:71], v[204:207], v[148:151], v[56:71]
ds_read_b64_tr_b16 v[204:205], v3 offset:49152
ds_read_b64_tr_b16 v[206:207], v3 offset:49664
s_waitcnt vmcnt(9) lgkmcnt(12)
s_nop 0
v_mfma_f32_32x32x16_bf16 v[8:23], v[208:211], v[252:255], v[8:23]
buffer_load_dwordx4 v[72:75], v7, s[44:47], s69 offen offset:0 sc1
v_mfma_f32_32x32x16_bf16 v[24:39], v[212:215], v[252:255], v[24:39]
s_waitcnt vmcnt(9)
s_nop 0
v_mfma_f32_32x32x16_bf16 v[40:55], v[208:211], v[152:155], v[40:55]
ds_read_b64_tr_b16 v[208:209], v2 offset:51200
ds_read_b64_tr_b16 v[210:211], v2 offset:51712
buffer_load_dwordx4 v[76:79], v7, s[44:47], s69 offen offset:64 sc1
v_mfma_f32_32x32x16_bf16 v[56:71], v[212:215], v[152:155], v[56:71]
ds_read_b64_tr_b16 v[212:213], v3 offset:51200
ds_read_b64_tr_b16 v[214:215], v3 offset:51712
s_waitcnt vmcnt(9) lgkmcnt(12)
s_nop 0
v_mfma_f32_32x32x16_bf16 v[8:23], v[184:187], v[108:111], v[8:23]
s_add_u32 s77, s77, 4096
s_cmp_ge_u32 s77, s101
s_cselect_b32 s77, 0, s77
buffer_load_dwordx4 v[116:119], v1, s[56:59], s77 offen offset:0 sc1
v_mfma_f32_32x32x16_bf16 v[24:39], v[188:191], v[108:111], v[24:39]
s_waitcnt vmcnt(9)
s_nop 0
v_mfma_f32_32x32x16_bf16 v[40:55], v[184:187], v[156:159], v[40:55]
ds_read_b64_tr_b16 v[184:185], v2 offset:32768
ds_read_b64_tr_b16 v[186:187], v2 offset:33280
buffer_load_dwordx4 v[172:175], v1, s[56:59], s77 offen offset:1024 sc1
v_mfma_f32_32x32x16_bf16 v[56:71], v[188:191], v[156:159], v[56:71]
ds_read_b64_tr_b16 v[188:189], v3 offset:32768
ds_read_b64_tr_b16 v[190:191], v3 offset:33280
s_waitcnt vmcnt(9) lgkmcnt(12)
s_nop 0
v_mfma_f32_32x32x16_bf16 v[8:23], v[192:195], v[216:219], v[8:23]
buffer_load_dwordx4 v[224:227], v1, s[56:59], s77 offen offset:2048 sc1
v_mfma_f32_32x32x16_bf16 v[24:39], v[196:199], v[216:219], v[24:39]
s_waitcnt vmcnt(9)
s_nop 0
v_mfma_f32_32x32x16_bf16 v[40:55], v[192:195], v[160:163], v[40:55]
ds_read_b64_tr_b16 v[192:193], v2 offset:34816
ds_read_b64_tr_b16 v[194:195], v2 offset:35328
buffer_load_dwordx4 v[176:179], v1, s[56:59], s77 offen offset:3072 sc1
v_mfma_f32_32x32x16_bf16 v[56:71], v[196:199], v[160:163], v[56:71]
ds_read_b64_tr_b16 v[196:197], v3 offset:34816
ds_read_b64_tr_b16 v[198:199], v3 offset:35328
s_waitcnt vmcnt(9) lgkmcnt(12)
s_nop 0
v_mfma_f32_32x32x16_bf16 v[8:23], v[200:203], v[112:115], v[8:23]
s_add_u32 s77, s77, 4096
s_cmp_ge_u32 s77, s101
s_cselect_b32 s77, 0, s77
buffer_load_dwordx4 v[120:123], v1, s[56:59], s77 offen offset:0 sc1
v_mfma_f32_32x32x16_bf16 v[24:39], v[204:207], v[112:115], v[24:39]
s_waitcnt vmcnt(9)
s_nop 0
v_mfma_f32_32x32x16_bf16 v[40:55], v[200:203], v[164:167], v[40:55]
ds_read_b64_tr_b16 v[200:201], v2 offset:16384
ds_read_b64_tr_b16 v[202:203], v2 offset:16896
buffer_load_dwordx4 v[180:183], v1, s[56:59], s77 offen offset:1024 sc1
v_mfma_f32_32x32x16_bf16 v[56:71], v[204:207], v[164:167], v[56:71]
ds_read_b64_tr_b16 v[204:205], v3 offset:16384
ds_read_b64_tr_b16 v[206:207], v3 offset:16896
s_waitcnt vmcnt(9) lgkmcnt(12)
s_nop 0
v_mfma_f32_32x32x16_bf16 v[8:23], v[208:211], v[220:223], v[8:23]
buffer_load_dwordx4 v[228:231], v1, s[56:59], s77 offen offset:2048 sc1
v_mfma_f32_32x32x16_bf16 v[24:39], v[212:215], v[220:223], v[24:39]
s_waitcnt vmcnt(9)
s_nop 0
v_mfma_f32_32x32x16_bf16 v[40:55], v[208:211], v[168:171], v[40:55]
ds_read_b64_tr_b16 v[208:209], v2 offset:18432
ds_read_b64_tr_b16 v[210:211], v2 offset:18944
buffer_load_dwordx4 v[124:127], v1, s[56:59], s77 offen offset:3072 sc1
v_mfma_f32_32x32x16_bf16 v[56:71], v[212:215], v[168:171], v[56:71]
ds_read_b64_tr_b16 v[212:213], v3 offset:18432
ds_read_b64_tr_b16 v[214:215], v3 offset:18944
s_waitcnt vmcnt(7) lgkmcnt(12)
s_nop 0
v_mfma_f32_32x32x16_bf16 v[8:23], v[184:187], v[116:119], v[8:23]
s_add_u32 s77, s77, 4096
s_cmp_ge_u32 s77, s101
s_cselect_b32 s77, 0, s77
buffer_load_dwordx4 v[232:235], v1, s[56:59], s77 offen offset:0 sc1
v_mfma_f32_32x32x16_bf16 v[24:39], v[188:191], v[116:119], v[24:39]
buffer_load_dwordx4 v[128:131], v1, s[56:59], s77 offen offset:1024 sc1
s_waitcnt vmcnt(8)
s_nop 0
v_mfma_f32_32x32x16_bf16 v[40:55], v[184:187], v[172:175], v[40:55]
ds_read_b64_tr_b16 v[184:185], v2 offset:0
ds_read_b64_tr_b16 v[186:187], v2 offset:512
buffer_load_dwordx4 v[236:239], v1, s[56:59], s77 offen offset:2048 sc1
v_mfma_f32_32x32x16_bf16 v[56:71], v[188:191], v[172:175], v[56:71]
ds_read_b64_tr_b16 v[188:189], v3 offset:0
ds_read_b64_tr_b16 v[190:191], v3 offset:512
buffer_load_dwordx4 v[132:135], v1, s[56:59], s77 offen offset:3072 sc1
s_waitcnt vmcnt(9) lgkmcnt(12)
s_nop 0
v_mfma_f32_32x32x16_bf16 v[8:23], v[192:195], v[224:227], v[8:23]
v_mfma_f32_32x32x16_bf16 v[24:39], v[196:199], v[224:227], v[24:39]
s_waitcnt vmcnt(8)
s_nop 0
v_mfma_f32_32x32x16_bf16 v[40:55], v[192:195], v[176:179], v[40:55]
ds_read_b64_tr_b16 v[192:193], v2 offset:2048
ds_read_b64_tr_b16 v[194:195], v2 offset:2560
v_mfma_f32_32x32x16_bf16 v[56:71], v[196:199], v[176:179], v[56:71]
ds_read_b64_tr_b16 v[196:197], v3 offset:2048
ds_read_b64_tr_b16 v[198:199], v3 offset:2560
s_waitcnt vmcnt(7) lgkmcnt(12)
s_nop 0
v_mfma_f32_32x32x16_bf16 v[8:23], v[200:203], v[120:123], v[8:23]
v_mfma_f32_32x32x16_bf16 v[24:39], v[204:207], v[120:123], v[24:39]
s_waitcnt vmcnt(6)
s_nop 0
v_mfma_f32_32x32x16_bf16 v[40:55], v[200:203], v[180:183], v[40:55]
v_mfma_f32_32x32x16_bf16 v[56:71], v[204:207], v[180:183], v[56:71]
s_waitcnt vmcnt(5) lgkmcnt(8)
s_nop 0
v_mfma_f32_32x32x16_bf16 v[8:23], v[208:211], v[228:231], v[8:23]
v_mfma_f32_32x32x16_bf16 v[24:39], v[212:215], v[228:231], v[24:39]
s_waitcnt vmcnt(4)
s_nop 0
v_mfma_f32_32x32x16_bf16 v[40:55], v[208:211], v[124:127], v[40:55]
v_mfma_f32_32x32x16_bf16 v[56:71], v[212:215], v[124:127], v[56:71]
s_waitcnt vmcnt(0) lgkmcnt(0)
s_nop 0
v_mfma_f32_32x32x16_bf16 v[8:23], v[184:187], v[232:235], v[8:23]
v_mfma_f32_32x32x16_bf16 v[8:23], v[192:195], v[236:239], v[8:23]
v_mfma_f32_32x32x16_bf16 v[24:39], v[188:191], v[232:235], v[24:39]
v_cndmask_b32 v96, v72, v73, s[74:75]
v_cndmask_b32 v98, v76, v77, s[74:75]
v_sub_f32 v100, 1.0, v96
v_sub_f32 v101, 1.0, v98
v_cvt_pk_bf16_f32 v100, v100, v101
v_mfma_f32_32x32x16_bf16 v[24:39], v[196:199], v[236:239], v[24:39]
v_and_b32 v102, 0xffff0000, v100
v_lshlrev_b32 v100, 16, v100
v_cmp_eq_u64 vcc, s[30:31], v[74:75]
v_cmp_eq_u64 s[64:65], s[30:31], v[78:79]
v_mfma_f32_32x32x16_bf16 v[40:55], v[184:187], v[128:131], v[40:55]
ds_write_b128 v80, v[8:11] offset:32768
ds_write_b128 v81, v[12:15] offset:32768
ds_write_b128 v82, v[16:19] offset:32768
ds_write_b128 v83, v[20:23] offset:32768
v_mfma_f32_32x32x16_bf16 v[40:55], v[192:195], v[132:135], v[40:55]
s_nop 1
ds_write_b128 v84, v[24:27] offset:32768
ds_write_b128 v85, v[28:31] offset:32768
v_mfma_f32_32x32x16_bf16 v[56:71], v[188:191], v[128:131], v[56:71]
ds_write_b128 v86, v[32:35] offset:32768
ds_write_b128 v87, v[36:39] offset:32768
v_mfma_f32_32x32x16_bf16 v[56:71], v[196:199], v[132:135], v[56:71]
s_nop 3
ds_write_b128 v80, v[40:43] offset:0
ds_write_b128 v81, v[44:47] offset:0
ds_write_b128 v82, v[48:51] offset:0
ds_write_b128 v83, v[52:55] offset:0
s_nop 3
ds_write_b128 v84, v[56:59] offset:0
ds_write_b128 v85, v[60:63] offset:0
ds_write_b128 v86, v[64:67] offset:0
ds_write_b128 v87, v[68:71] offset:0
KL_FIN:
s_and_b64 s[64:65], s[64:65], vcc
s_andn2_b64 s[64:65], exec, s[64:65]
s_cbranch_scc0 GD_13
s_mov_b32 s66, 0x40000
GL_12:
s_sleep 1
buffer_load_dwordx4 v[72:75], v7, s[44:47], s69 offen sc1
buffer_load_dwordx4 v[76:79], v7, s[44:47], s69 offen offset:64 sc1
s_waitcnt vmcnt(0)
v_cndmask_b32 v96, v72, v73, s[74:75]
v_cndmask_b32 v98, v76, v77, s[74:75]
v_sub_f32 v100, 1.0, v96
v_sub_f32 v101, 1.0, v98
v_cvt_pk_bf16_f32 v100, v100, v101
v_and_b32 v102, 0xffff0000, v100
v_lshlrev_b32 v100, 16, v100
v_cmp_eq_u64 vcc, s[30:31], v[74:75]
v_cmp_eq_u64 s[64:65], s[30:31], v[78:79]
s_nop 0
s_and_b64 s[64:65], s[64:65], vcc
s_andn2_b64 s[64:65], exec, s[64:65]
s_cbranch_scc0 GD_13
s_sub_u32 s66, s66, 1
s_cmp_lg_u32 s66, 0
s_cbranch_scc1 GL_12
GD_13:
v_mov_b32 v99, v102
ds_write_b64 v103, v[98:99]
s_waitcnt lgkmcnt(0)
s_barrier
ds_read_b128 v[104:107], v88 offset:12288
ds_read_b128 v[108:111], v89 offset:12288
ds_read_b128 v[112:115], v88 offset:24576
ds_read_b128 v[116:119], v89 offset:24576
ds_read_b128 v[120:123], v88 offset:20480
ds_read_b128 v[124:127], v89 offset:20480
ds_read_b128 v[128:131], v88 offset:16384
ds_read_b128 v[132:135], v89 offset:16384
s_waitcnt lgkmcnt(6)
v_pk_mul_f32 v[104:105], v[104:105], v[96:97] op_sel_hi:[1,0]
v_pk_mul_f32 v[106:107], v[106:107], v[96:97] op_sel_hi:[1,0]
v_pk_mul_f32 v[108:109], v[108:109], v[96:97] op_sel_hi:[1,0]
v_pk_mul_f32 v[110:111], v[110:111], v[96:97] op_sel_hi:[1,0]
s_waitcnt lgkmcnt(2)
v_pk_add_f32 v[112:113], v[112:113], v[120:121]
v_pk_add_f32 v[114:115], v[114:115], v[122:123]
v_pk_add_f32 v[116:117], v[116:117], v[124:125]
v_pk_add_f32 v[118:119], v[118:119], v[126:127]
s_waitcnt lgkmcnt(0)
v_pk_add_f32 v[112:113], v[112:113], v[128:129]
v_pk_add_f32 v[114:115], v[114:115], v[130:131]
v_pk_add_f32 v[116:117], v[116:117], v[132:133]
v_pk_add_f32 v[118:119], v[118:119], v[134:135]
v_pk_fma_f32 v[104:105], v[112:113], v[100:101], v[104:105] op_sel_hi:[1,0,1]
v_pk_fma_f32 v[106:107], v[114:115], v[100:101], v[106:107] op_sel_hi:[1,0,1]
v_pk_fma_f32 v[108:109], v[116:117], v[100:101], v[108:109] op_sel_hi:[1,0,1]
v_pk_fma_f32 v[110:111], v[118:119], v[100:101], v[110:111] op_sel_hi:[1,0,1]
v_cvt_pk_bf16_f32 v120, v104, v105
v_cvt_pk_bf16_f32 v121, v106, v107
v_cvt_pk_bf16_f32 v122, v108, v109
v_cvt_pk_bf16_f32 v123, v110, v111
buffer_store_dwordx4 v[120:123], v92, s[52:55], s70 offen sc1
K_END:
s_endpgm
K_COMPUTE:
s_cmp_eq_u32 s25, 0
s_cbranch_scc1 K_ATTN
s_lshr_b32 s68, s27, 1
s_and_b32 s69, s27, 1
v_and_b32 v10, 15, v0
v_lshrrev_b32 v11, 4, v0
v_lshrrev_b32 v12, 1, v10
v_xor_b32 v12, v12, v11
v_lshlrev_b32 v12, 4, v12
v_lshlrev_b32 v13, 7, v10
v_add_u32 v12, v12, v13
s_lshl_b32 s64, s68, 13
v_add_u32 v2, s64, v12
v_xor_b32 v3, 64, v2
v_bfe_u32 v12, v0, 2, 2
v_lshlrev_b32 v13, 3, v11
v_add_u32 v13, v13, v12
v_lshrrev_b32 v14, 1, v12
v_and_b32 v15, 1, v11
v_lshlrev_b32 v9, 1, v15
v_or_b32 v14, v14, v9
v_and_b32 v9, 3, v0
v_lshlrev_b32 v9, 3, v9
v_lshlrev_b32 v12, 7, v13
v_add_u32 v12, v12, v9
s_mul_i32 s64, s69, 6
s_add_u32 s64, s64, 0
s_and_b32 s65, s64, 3
s_lshr_b32 s64, s64, 2
s_lshl_b32 s64, s64, 13
s_add_u32 s64, s64, 16384
v_xor_b32 v4, s65, v14
v_lshlrev_b32 v4, 5, v4
v_add_u32 v4, v4, v12
v_add_u32 v4, s64, v4
s_mul_i32 s64, s69, 6
s_add_u32 s64, s64, 1
s_and_b32 s65, s64, 3
s_lshr_b32 s64, s64, 2
s_lshl_b32 s64, s64, 13
s_add_u32 s64, s64, 16384
v_xor_b32 v5, s65, v14
v_lshlrev_b32 v5, 5, v5
v_add_u32 v5, v5, v12
v_add_u32 v5, s64, v5
s_mul_i32 s64, s69, 6
s_add_u32 s64, s64, 2
s_and_b32 s65, s64, 3
s_lshr_b32 s64, s64, 2
s_lshl_b32 s64, s64, 13
s_add_u32 s64, s64, 16384
v_xor_b32 v6, s65, v14
v_lshlrev_b32 v6, 5, v6
v_add_u32 v6, v6, v12
v_add_u32 v6, s64, v6
s_mul_i32 s64, s69, 6
s_add_u32 s64, s64, 3
s_and_b32 s65, s64, 3
s_lshr_b32 s64, s64, 2
s_lshl_b32 s64, s64, 13
s_add_u32 s64, s64, 16384
v_xor_b32 v7, s65, v14
v_lshlrev_b32 v7, 5, v7
v_add_u32 v7, v7, v12
v_add_u32 v7, s64, v7
v_xor_b32 v8, s69, v15
v_lshlrev_b32 v8, 5, v8
v_add_u32 v8, v8, v9
v_lshlrev_b32 v12, 6, v13
v_add_u32 v8, v8, v12
v_add_u32 v8, 40960, v8
s_lshl_b32 s64, s24, 1
s_add_u32 s64, s64, s68
s_mul_i32 s64, s64, 72
s_mul_i32 s65, s26, 7
s_add_u32 s64, s64, s65
s_add_u32 s64, s64, 16
s_and_b32 s65, s26, 1
s_mul_i32 s66, s69, 3
s_add_u32 s66, s66, s65
s_add_u32 s66, s66, s64
s_lshl_b32 s74, s66, 12
s_add_u32 s75, s74, 4096
s_add_u32 s76, s74, 8192
s_cmp_eq_u32 s65, 0
s_cselect_b32 s66, 6, 0
s_add_u32 s66, s66, s64
s_lshl_b32 s77, s66, 12
s_lshl_b32 s65, s69, 11
s_add_u32 s77, s77, s65
v_lshlrev_b32 v9, 4, v0
s_waitcnt lgkmcnt(0)
v_mov_b32 v1, 0
s_or_b32 s64, s2, s3
s_cmp_lg_u32 s64, 0
s_cbranch_scc1 CS_14
s_memrealtime s[64:65]
s_waitcnt lgkmcnt(0)
s_or_b32 s64, s64, 1
s_xor_b32 s65, s65, 0x5bd1e995
v_mov_b32 v10, s64
v_mov_b32 v11, s65
s_mov_b64 exec, 1
global_store_dwordx2 v1, v[10:11], s[20:21] sc1
s_mov_b64 exec, -1
CS_14:
s_mov_b32 s44, s22
s_mov_b32 s45, s23
s_mov_b32 s46, 14155776
s_mov_b32 s47, 0x20000
s_lshl_b32 s78, s24, 4
s_lshl_b32 s64, s25, 3
s_add_u32 s78, s78, s64
s_add_u32 s78, s78, s26
s_mul_i32 s78, s78, 1152
s_add_u32 s78, s78, 13762560
v_mov_b32 v16, 0
v_mov_b32 v17, 0
v_mov_b32 v18, 0
v_mov_b32 v19, 0
v_mov_b32 v20, 0
v_mov_b32 v21, 0
v_mov_b32 v22, 0
v_mov_b32 v23, 0
v_mov_b32 v24, 0
v_mov_b32 v25, 0
v_mov_b32 v26, 0
v_mov_b32 v27, 0
v_mov_b32 v28, 0
v_mov_b32 v29, 0
v_mov_b32 v30, 0
v_mov_b32 v31, 0
v_mov_b32 v32, 0
v_mov_b32 v33, 0
v_mov_b32 v34, 0
v_mov_b32 v35, 0
v_mov_b32 v36, 0
v_mov_b32 v37, 0
v_mov_b32 v38, 0
v_mov_b32 v39, 0
v_mov_b32 v40, 0
v_mov_b32 v41, 0
v_mov_b32 v42, 0
v_mov_b32 v43, 0
v_mov_b32 v44, 0
v_mov_b32 v45, 0
v_mov_b32 v46, 0
v_mov_b32 v47, 0
v_mov_b32 v48, 0
v_mov_b32 v49, 0
v_mov_b32 v50, 0
v_mov_b32 v51, 0
v_mov_b32 v52, 0
v_mov_b32 v53, 0
v_mov_b32 v54, 0
v_mov_b32 v55, 0
v_mov_b32 v56, 0
v_mov_b32 v57, 0
v_mov_b32 v58, 0
v_mov_b32 v59, 0
v_mov_b32 v60, 0
v_mov_b32 v61, 0
v_mov_b32 v62, 0
v_mov_b32 v63, 0
v_mov_b32 v64, 0
v_mov_b32 v65, 0
v_mov_b32 v66, 0
v_mov_b32 v67, 0
v_mov_b32 v68, 0
v_mov_b32 v69, 0
v_mov_b32 v70, 0
v_mov_b32 v71, 0
v_mov_b32 v72, 0
v_mov_b32 v73, 0
v_mov_b32 v74, 0
v_mov_b32 v75, 0
v_mov_b32 v76, 0
v_mov_b32 v77, 0
v_mov_b32 v78, 0
v_mov_b32 v79, 0
v_mov_b32 v80, 0
v_mov_b32 v81, 0
v_mov_b32 v82, 0
v_mov_b32 v83, 0
v_mov_b32 v84, 0
v_mov_b32 v85, 0
v_mov_b32 v86, 0
v_mov_b32 v87, 0
v_mov_b32 v88, 0
v_mov_b32 v89, 0
v_mov_b32 v90, 0
v_mov_b32 v91, 0
v_mov_b32 v92, 0
v_mov_b32 v93, 0
v_mov_b32 v94, 0
v_mov_b32 v95, 0
v_mov_b32 v96, 0
v_mov_b32 v97, 0
v_mov_b32 v98, 0
v_mov_b32 v99, 0
v_mov_b32 v100, 0
v_mov_b32 v101, 0
v_mov_b32 v102, 0
v_mov_b32 v103, 0
v_mov_b32 v104, 0
v_mov_b32 v105, 0
v_mov_b32 v106, 0
v_mov_b32 v107, 0
v_mov_b32 v108, 0
v_mov_b32 v109, 0
v_mov_b32 v110, 0
v_mov_b32 v111, 0
v_mov_b32 v112, 0
v_mov_b32 v113, 0
v_mov_b32 v114, 0
v_mov_b32 v115, 0
v_mov_b32 v116, 0
v_mov_b32 v117, 0
v_mov_b32 v118, 0
v_mov_b32 v119, 0
v_mov_b32 v120, 0
v_mov_b32 v121, 0
v_mov_b32 v122, 0
v_mov_b32 v123, 0
v_mov_b32 v124, 0
v_mov_b32 v125, 0
v_mov_b32 v126, 0
v_mov_b32 v127, 0
s_mov_b32 s70, 1
s_mov_b32 s72, 0
s_mov_b32 s73, 4294922240
s_mov_b32 s79, 90112
v_add_u32 v2, 45056, v2
v_add_u32 v3, 45056, v3
v_add_u32 v4, 45056, v4
v_add_u32 v5, 45056, v5
v_add_u32 v6, 45056, v6
v_add_u32 v7, 45056, v7
v_add_u32 v8, 45056, v8
s_barrier
ds_read_b128 v[128:131], v2 offset:0
ds_read_b64_tr_b16 v[144:145], v4 offset:0
ds_read_b64_tr_b16 v[146:147], v4 offset:512
ds_read_b64_tr_b16 v[148:149], v5 offset:0
ds_read_b64_tr_b16 v[150:151], v5 offset:512
ds_read_b128 v[132:135], v2 offset:2048
ds_read_b64_tr_b16 v[152:153], v6 offset:0
ds_read_b64_tr_b16 v[154:155], v6 offset:512
ds_read_b64_tr_b16 v[156:157], v7 offset:0
ds_read_b128 v[136:139], v2 offset:4096
ds_read_b64_tr_b16 v[158:159], v7 offset:512
ds_read_b64_tr_b16 v[160:161], v4 offset:8192
ds_read_b64_tr_b16 v[162:163], v4 offset:8704
ds_read_b64_tr_b16 v[164:165], v5 offset:8192
ds_read_b128 v[140:143], v2 offset:6144
ds_read_b64_tr_b16 v[166:167], v5 offset:8704
ds_read_b64_tr_b16 v[168:169], v8 offset:0
ds_read_b64_tr_b16 v[170:171], v8 offset:256
.p2align 3
KF_LOOP:
s_waitcnt lgkmcnt(0)
s_add_u32 s70, s70, 1
v_mfma_f32_16x16x32_bf16 v[16:19], v[144:147], v[128:131], v[16:19]
ds_read_b128 v[172:175], v3 offset:0
v_mfma_f32_16x16x32_bf16 v[44:47], v[144:147], v[132:135], v[44:47]
v_mfma_f32_16x16x32_bf16 v[72:75], v[144:147], v[136:139], v[72:75]
ds_read_b64_tr_b16 v[188:189], v4 offset:4096
v_mfma_f32_16x16x32_bf16 v[100:103], v[144:147], v[140:143], v[100:103]
ds_read_b64_tr_b16 v[190:191], v4 offset:4608
v_mfma_f32_16x16x32_bf16 v[20:23], v[148:151], v[128:131], v[20:23]
ds_read_b64_tr_b16 v[192:193], v5 offset:4096
v_mfma_f32_16x16x32_bf16 v[48:51], v[148:151], v[132:135], v[48:51]
ds_read_b64_tr_b16 v[194:195], v5 offset:4608
v_mfma_f32_16x16x32_bf16 v[76:79], v[148:151], v[136:139], v[76:79]
v_mfma_f32_16x16x32_bf16 v[104:107], v[148:151], v[140:143], v[104:107]
ds_read_b128 v[176:179], v3 offset:2048
v_mfma_f32_16x16x32_bf16 v[24:27], v[152:155], v[128:131], v[24:27]
ds_read_b64_tr_b16 v[196:197], v6 offset:4096
v_mfma_f32_16x16x32_bf16 v[52:55], v[152:155], v[132:135], v[52:55]
ds_read_b64_tr_b16 v[198:199], v6 offset:4608
v_mfma_f32_16x16x32_bf16 v[80:83], v[152:155], v[136:139], v[80:83]
ds_read_b64_tr_b16 v[200:201], v7 offset:4096
v_mfma_f32_16x16x32_bf16 v[108:111], v[152:155], v[140:143], v[108:111]
ds_read_b128 v[180:183], v3 offset:4096
v_mfma_f32_16x16x32_bf16 v[28:31], v[156:159], v[128:131], v[28:31]
v_mfma_f32_16x16x32_bf16 v[56:59], v[156:159], v[132:135], v[56:59]
ds_read_b64_tr_b16 v[202:203], v7 offset:4608
v_mfma_f32_16x16x32_bf16 v[84:87], v[156:159], v[136:139], v[84:87]
ds_read_b64_tr_b16 v[204:205], v4 offset:12288
v_mfma_f32_16x16x32_bf16 v[112:115], v[156:159], v[140:143], v[112:115]
ds_read_b64_tr_b16 v[206:207], v4 offset:12800
v_mfma_f32_16x16x32_bf16 v[32:35], v[160:163], v[128:131], v[32:35]
ds_read_b64_tr_b16 v[208:209], v5 offset:12288
v_mfma_f32_16x16x32_bf16 v[60:63], v[160:163], v[132:135], v[60:63]
v_mfma_f32_16x16x32_bf16 v[88:91], v[160:163], v[136:139], v[88:91]
ds_read_b128 v[184:187], v3 offset:6144
v_mfma_f32_16x16x32_bf16 v[116:119], v[160:163], v[140:143], v[116:119]
ds_read_b64_tr_b16 v[210:211], v5 offset:12800
v_mfma_f32_16x16x32_bf16 v[36:39], v[164:167], v[128:131], v[36:39]
ds_read_b64_tr_b16 v[212:213], v8 offset:2048
v_mfma_f32_16x16x32_bf16 v[64:67], v[164:167], v[132:135], v[64:67]
ds_read_b64_tr_b16 v[214:215], v8 offset:2304
v_mfma_f32_16x16x32_bf16 v[92:95], v[164:167], v[136:139], v[92:95]
s_cmp_eq_u32 s70, 3
s_cselect_b32 s71, s79, s73
v_mfma_f32_16x16x32_bf16 v[120:123], v[164:167], v[140:143], v[120:123]
s_cselect_b32 s70, 0, s70
s_add_u32 s72, s72, 1
v_mfma_f32_16x16x32_bf16 v[40:43], v[168:171], v[128:131], v[40:43]
s_cmp_eq_u32 s72, s101
s_cbranch_scc1 KF_DUTY
KF_DBACK:
v_mfma_f32_16x16x32_bf16 v[68:71], v[168:171], v[132:135], v[68:71]
s_cmp_eq_u32 s72, 8
s_nop 0
v_mfma_f32_16x16x32_bf16 v[96:99], v[168:171], v[136:139], v[96:99]
v_mfma_f32_16x16x32_bf16 v[124:127], v[168:171], v[140:143], v[124:127]
s_waitcnt lgkmcnt(0)
s_barrier
s_cbranch_scc1 KF_DONE
s_nop 0
v_mfma_f32_16x16x32_bf16 v[16:19], v[188:191], v[172:175], v[16:19]
v_add_u32 v2, s71, v2
v_add_u32 v3, s71, v3
v_mfma_f32_16x16x32_bf16 v[44:47], v[188:191], v[176:179], v[44:47]
v_add_u32 v4, s71, v4
v_add_u32 v5, s71, v5
v_mfma_f32_16x16x32_bf16 v[72:75], v[188:191], v[180:183], v[72:75]
v_add_u32 v6, s71, v6
v_add_u32 v7, s71, v7
v_mfma_f32_16x16x32_bf16 v[100:103], v[188:191], v[184:187], v[100:103]
v_add_u32 v8, s71, v8
s_nop 0
v_mfma_f32_16x16x32_bf16 v[20:23], v[192:195], v[172:175], v[20:23]
ds_read_b128 v[128:131], v2 offset:0
v_mfma_f32_16x16x32_bf16 v[48:51], v[192:195], v[176:179], v[48:51]
v_mfma_f32_16x16x32_bf16 v[76:79], v[192:195], v[180:183], v[76:79]
ds_read_b64_tr_b16 v[144:145], v4 offset:0
v_mfma_f32_16x16x32_bf16 v[104:107], v[192:195], v[184:187], v[104:107]
ds_read_b64_tr_b16 v[146:147], v4 offset:512
v_mfma_f32_16x16x32_bf16 v[24:27], v[196:199], v[172:175], v[24:27]
ds_read_b64_tr_b16 v[148:149], v5 offset:0
v_mfma_f32_16x16x32_bf16 v[52:55], v[196:199], v[176:179], v[52:55]
ds_read_b64_tr_b16 v[150:151], v5 offset:512
v_mfma_f32_16x16x32_bf16 v[80:83], v[196:199], v[180:183], v[80:83]
v_mfma_f32_16x16x32_bf16 v[108:111], v[196:199], v[184:187], v[108:111]
ds_read_b128 v[132:135], v2 offset:2048
v_mfma_f32_16x16x32_bf16 v[28:31], v[200:203], v[172:175], v[28:31]
ds_read_b64_tr_b16 v[152:153], v6 offset:0
v_mfma_f32_16x16x32_bf16 v[56:59], v[200:203], v[176:179], v[56:59]
ds_read_b64_tr_b16 v[154:155], v6 offset:512
v_mfma_f32_16x16x32_bf16 v[84:87], v[200:203], v[180:183], v[84:87]
ds_read_b64_tr_b16 v[156:157], v7 offset:0
v_mfma_f32_16x16x32_bf16 v[112:115], v[200:203], v[184:187], v[112:115]
ds_read_b128 v[136:139], v2 offset:4096
v_mfma_f32_16x16x32_bf16 v[32:35], v[204:207], v[172:175], v[32:35]
v_mfma_f32_16x16x32_bf16 v[60:63], v[204:207], v[176:179], v[60:63]
ds_read_b64_tr_b16 v[158:159], v7 offset:512
v_mfma_f32_16x16x32_bf16 v[88:91], v[204:207], v[180:183], v[88:91]
ds_read_b64_tr_b16 v[160:161], v4 offset:8192
v_mfma_f32_16x16x32_bf16 v[116:119], v[204:207], v[184:187], v[116:119]
ds_read_b64_tr_b16 v[162:163], v4 offset:8704
v_mfma_f32_16x16x32_bf16 v[36:39], v[208:211], v[172:175], v[36:39]
ds_read_b64_tr_b16 v[164:165], v5 offset:8192
v_mfma_f32_16x16x32_bf16 v[64:67], v[208:211], v[176:179], v[64:67]
v_mfma_f32_16x16x32_bf16 v[92:95], v[208:211], v[180:183], v[92:95]
ds_read_b128 v[140:143], v2 offset:6144
v_mfma_f32_16x16x32_bf16 v[120:123], v[208:211], v[184:187], v[120:123]
ds_read_b64_tr_b16 v[166:167], v5 offset:8704
v_mfma_f32_16x16x32_bf16 v[40:43], v[212:215], v[172:175], v[40:43]
ds_read_b64_tr_b16 v[168:169], v8 offset:0
v_mfma_f32_16x16x32_bf16 v[68:71], v[212:215], v[176:179], v[68:71]
ds_read_b64_tr_b16 v[170:171], v8 offset:256
v_mfma_f32_16x16x32_bf16 v[96:99], v[212:215], v[180:183], v[96:99]
v_mfma_f32_16x16x32_bf16 v[124:127], v[212:215], v[184:187], v[124:127]
s_branch KF_LOOP
KF_DUTY:
buffer_load_dword v255, v254, s[48:51], s100 offen
s_branch KF_DBACK
.p2align 3
KF_DONE:
s_setprio 3
s_nop 0
v_mfma_f32_16x16x32_bf16 v[16:19], v[188:191], v[172:175], v[16:19]
global_load_dwordx2 v[10:11], v1, s[20:21] sc1
v_mfma_f32_16x16x32_bf16 v[44:47], v[188:191], v[176:179], v[44:47]
v_mfma_f32_16x16x32_bf16 v[72:75], v[188:191], v[180:183], v[72:75]
v_mfma_f32_16x16x32_bf16 v[100:103], v[188:191], v[184:187], v[100:103]
v_mfma_f32_16x16x32_bf16 v[20:23], v[192:195], v[172:175], v[20:23]
v_mfma_f32_16x16x32_bf16 v[48:51], v[192:195], v[176:179], v[48:51]
v_mfma_f32_16x16x32_bf16 v[76:79], v[192:195], v[180:183], v[76:79]
v_mfma_f32_16x16x32_bf16 v[104:107], v[192:195], v[184:187], v[104:107]
v_cvt_pk_bf16_f32 v128, v16, v17
v_cvt_pk_bf16_f32 v129, v18, v19
v_mfma_f32_16x16x32_bf16 v[24:27], v[196:199], v[172:175], v[24:27]
v_cvt_pk_bf16_f32 v130, v44, v45
v_cvt_pk_bf16_f32 v131, v46, v47
v_mfma_f32_16x16x32_bf16 v[52:55], v[196:199], v[176:179], v[52:55]
v_pk_max_i16 v128, v128, 0
v_pk_max_i16 v130, v130, 0
v_mfma_f32_16x16x32_bf16 v[80:83], v[196:199], v[180:183], v[80:83]
v_pk_max_i16 v129, v129, 0
v_pk_max_i16 v131, v131, 0
v_mfma_f32_16x16x32_bf16 v[108:111], v[196:199], v[184:187], v[108:111]
v_permlane16_swap_b32 v128, v130
v_permlane16_swap_b32 v129, v131
v_mfma_f32_16x16x32_bf16 v[28:31], v[200:203], v[172:175], v[28:31]
buffer_store_dwordx4 v[128:131], v9, s[44:47], s74 offen offset:0 sc1
v_mfma_f32_16x16x32_bf16 v[56:59], v[200:203], v[176:179], v[56:59]
v_cvt_pk_bf16_f32 v132, v72, v73
v_cvt_pk_bf16_f32 v133, v74, v75
v_mfma_f32_16x16x32_bf16 v[84:87], v[200:203], v[180:183], v[84:87]
v_cvt_pk_bf16_f32 v134, v100, v101
v_cvt_pk_bf16_f32 v135, v102, v103
v_mfma_f32_16x16x32_bf16 v[112:115], v[200:203], v[184:187], v[112:115]
v_pk_max_i16 v132, v132, 0
v_pk_max_i16 v134, v134, 0
v_mfma_f32_16x16x32_bf16 v[32:35], v[204:207], v[172:175], v[32:35]
v_pk_max_i16 v133, v133, 0
v_pk_max_i16 v135, v135, 0
v_mfma_f32_16x16x32_bf16 v[60:63], v[204:207], v[176:179], v[60:63]
v_permlane16_swap_b32 v132, v134
v_permlane16_swap_b32 v133, v135
v_mfma_f32_16x16x32_bf16 v[88:91], v[204:207], v[180:183], v[88:91]
buffer_store_dwordx4 v[132:135], v9, s[44:47], s74 offen offset:1024 sc1
v_mfma_f32_16x16x32_bf16 v[116:119], v[204:207], v[184:187], v[116:119]
v_cvt_pk_bf16_f32 v136, v20, v21
v_cvt_pk_bf16_f32 v137, v22, v23
v_mfma_f32_16x16x32_bf16 v[36:39], v[208:211], v[172:175], v[36:39]
v_cvt_pk_bf16_f32 v138, v48, v49
v_cvt_pk_bf16_f32 v139, v50, v51
v_mfma_f32_16x16x32_bf16 v[64:67], v[208:211], v[176:179], v[64:67]
v_pk_max_i16 v136, v136, 0
v_pk_max_i16 v138, v138, 0
v_mfma_f32_16x16x32_bf16 v[92:95], v[208:211], v[180:183], v[92:95]
v_pk_max_i16 v137, v137, 0
v_pk_max_i16 v139, v139, 0
v_mfma_f32_16x16x32_bf16 v[120:123], v[208:211], v[184:187], v[120:123]
v_permlane16_swap_b32 v136, v138
v_permlane16_swap_b32 v137, v139
v_mfma_f32_16x16x32_bf16 v[40:43], v[212:215], v[172:175], v[40:43]
buffer_store_dwordx4 v[136:139], v9, s[44:47], s74 offen offset:2048 sc1
v_mfma_f32_16x16x32_bf16 v[68:71], v[212:215], v[176:179], v[68:71]
v_cvt_pk_bf16_f32 v140, v76, v77
v_cvt_pk_bf16_f32 v141, v78, v79
v_mfma_f32_16x16x32_bf16 v[96:99], v[212:215], v[180:183], v[96:99]
v_cvt_pk_bf16_f32 v142, v104, v105
v_cvt_pk_bf16_f32 v143, v106, v107
v_mfma_f32_16x16x32_bf16 v[124:127], v[212:215], v[184:187], v[124:127]
v_pk_max_i16 v140, v140, 0
v_pk_max_i16 v142, v142, 0
v_pk_max_i16 v141, v141, 0
v_pk_max_i16 v143, v143, 0
v_permlane16_swap_b32 v140, v142
v_cvt_pk_bf16_f32 v144, v24, v25
v_permlane16_swap_b32 v141, v143
buffer_store_dwordx4 v[140:143], v9, s[44:47], s74 offen offset:3072 sc1
v_cvt_pk_bf16_f32 v145, v26, v27
v_cvt_pk_bf16_f32 v146, v52, v53
v_cvt_pk_bf16_f32 v147, v54, v55
v_pk_max_i16 v144, v144, 0
v_pk_max_i16 v146, v146, 0
v_pk_max_i16 v145, v145, 0
v_pk_max_i16 v147, v147, 0
v_permlane16_swap_b32 v144, v146
v_cvt_pk_bf16_f32 v148, v80, v81
v_permlane16_swap_b32 v145, v147
buffer_store_dwordx4 v[144:147], v9, s[44:47], s75 offen offset:0 sc1
v_cvt_pk_bf16_f32 v149, v82, v83
v_cvt_pk_bf16_f32 v150, v108, v109
v_cvt_pk_bf16_f32 v151, v110, v111
v_pk_max_i16 v148, v148, 0
v_pk_max_i16 v150, v150, 0
v_pk_max_i16 v149, v149, 0
v_pk_max_i16 v151, v151, 0
v_permlane16_swap_b32 v148, v150
v_cvt_pk_bf16_f32 v152, v28, v29
v_permlane16_swap_b32 v149, v151
buffer_store_dwordx4 v[148:151], v9, s[44:47], s75 offen offset:1024 sc1
v_cvt_pk_bf16_f32 v153, v30, v31
v_cvt_pk_bf16_f32 v154, v56, v57
v_cvt_pk_bf16_f32 v155, v58, v59
v_pk_max_i16 v152, v152, 0
v_pk_max_i16 v154, v154, 0
v_pk_max_i16 v153, v153, 0
v_pk_max_i16 v155, v155, 0
v_permlane16_swap_b32 v152, v154
v_cvt_pk_bf16_f32 v156, v84, v85
v_permlane16_swap_b32 v153, v155
buffer_store_dwordx4 v[152:155], v9, s[44:47], s75 offen offset:2048 sc1
v_cvt_pk_bf16_f32 v157, v86, v87
v_cvt_pk_bf16_f32 v158, v112, v113
v_cvt_pk_bf16_f32 v159, v114, v115
v_pk_max_i16 v156, v156, 0
v_pk_max_i16 v158, v158, 0
v_pk_max_i16 v157, v157, 0
v_pk_max_i16 v159, v159, 0
v_permlane16_swap_b32 v156, v158
v_cvt_pk_bf16_f32 v160, v32, v33
v_permlane16_swap_b32 v157, v159
buffer_store_dwordx4 v[156:159], v9, s[44:47], s75 offen offset:3072 sc1
v_cvt_pk_bf16_f32 v161, v34, v35
v_cvt_pk_bf16_f32 v162, v60, v61
v_cvt_pk_bf16_f32 v163, v62, v63
v_pk_max_i16 v160, v160, 0
v_pk_max_i16 v162, v162, 0
v_pk_max_i16 v161, v161, 0
v_pk_max_i16 v163, v163, 0
v_permlane16_swap_b32 v160, v162
v_cvt_pk_bf16_f32 v164, v88, v89
v_permlane16_swap_b32 v161, v163
buffer_store_dwordx4 v[160:163], v9, s[44:47], s76 offen offset:0 sc1
v_cvt_pk_bf16_f32 v165, v90, v91
v_cvt_pk_bf16_f32 v166, v116, v117
v_cvt_pk_bf16_f32 v167, v118, v119
v_pk_max_i16 v164, v164, 0
v_pk_max_i16 v166, v166, 0
v_pk_max_i16 v165, v165, 0
v_pk_max_i16 v167, v167, 0
v_permlane16_swap_b32 v164, v166
v_cvt_pk_bf16_f32 v168, v36, v37
v_permlane16_swap_b32 v165, v167
buffer_store_dwordx4 v[164:167], v9, s[44:47], s76 offen offset:1024 sc1
v_cvt_pk_bf16_f32 v169, v38, v39
v_cvt_pk_bf16_f32 v170, v64, v65
v_cvt_pk_bf16_f32 v171, v66, v67
v_pk_max_i16 v168, v168, 0
v_pk_max_i16 v170, v170, 0
v_pk_max_i16 v169, v169, 0
v_pk_max_i16 v171, v171, 0
v_permlane16_swap_b32 v168, v170
v_cvt_pk_bf16_f32 v216, v92, v93
v_permlane16_swap_b32 v169, v171
buffer_store_dwordx4 v[168:171], v9, s[44:47], s76 offen offset:2048 sc1
v_cvt_pk_bf16_f32 v217, v94, v95
v_cvt_pk_bf16_f32 v218, v120, v121
v_cvt_pk_bf16_f32 v219, v122, v123
v_pk_max_i16 v216, v216, 0
v_pk_max_i16 v218, v218, 0
v_pk_max_i16 v217, v217, 0
v_pk_max_i16 v219, v219, 0
v_permlane16_swap_b32 v216, v218
v_cvt_pk_bf16_f32 v220, v40, v41
v_permlane16_swap_b32 v217, v219
buffer_store_dwordx4 v[216:219], v9, s[44:47], s76 offen offset:3072 sc1
v_cvt_pk_bf16_f32 v221, v42, v43
v_cvt_pk_bf16_f32 v222, v68, v69
v_cvt_pk_bf16_f32 v223, v70, v71
v_pk_max_i16 v220, v220, 0
v_pk_max_i16 v222, v222, 0
v_pk_max_i16 v221, v221, 0
v_pk_max_i16 v223, v223, 0
v_permlane16_swap_b32 v220, v222
v_cvt_pk_bf16_f32 v224, v96, v97
v_permlane16_swap_b32 v221, v223
buffer_store_dwordx4 v[220:223], v9, s[44:47], s77 offen offset:0 sc1
v_cvt_pk_bf16_f32 v225, v98, v99
v_cvt_pk_bf16_f32 v226, v124, v125
v_cvt_pk_bf16_f32 v227, v126, v127
v_pk_max_i16 v224, v224, 0
v_pk_max_i16 v226, v226, 0
v_pk_max_i16 v225, v225, 0
v_pk_max_i16 v227, v227, 0
v_permlane16_swap_b32 v224, v226
s_nop 0
v_permlane16_swap_b32 v225, v227
buffer_store_dwordx4 v[224:227], v9, s[44:47], s77 offen offset:1024 sc1
s_mov_b64 exec, 1
v_mov_b32 v12, 159744
v_mov_b32 v13, 1
s_waitcnt vmcnt(14)
s_mov_b32 s64, 0x40000
TAGL_16:
v_readfirstlane_b32 s30, v10
v_readfirstlane_b32 s31, v11
s_nop 0
s_cmp_lg_u32 s30, 0
s_cbranch_scc1 TAGD_17
s_sub_u32 s64, s64, 1
s_cmp_eq_u32 s64, 0
s_cbranch_scc1 TAGD_17
s_sleep 2
global_load_dwordx2 v[10:11], v1, s[20:21] sc1
s_waitcnt vmcnt(0)
s_branch TAGL_16
TAGD_17:
s_waitcnt vmcnt(0)
ds_add_rtn_u32 v13, v12, v13
s_waitcnt lgkmcnt(0)
v_cmp_eq_u32 vcc, 3, v13
s_nop 0
s_cbranch_vccz NOPUB_15
buffer_store_dwordx2 v[10:11], v1, s[44:47], s78 offen sc1
NOPUB_15:
s_barrier
s_branch K_CFIN
K_ATTN:
v_and_b32 v10, 15, v0
v_lshrrev_b32 v11, 4, v0
v_lshrrev_b32 v12, 1, v10
v_xor_b32 v12, v12, v11
v_lshlrev_b32 v12, 4, v12
v_lshlrev_b32 v13, 7, v10
v_add_u32 v2, v12, v13
v_xor_b32 v3, 64, v2
v_bfe_u32 v12, v0, 2, 2
v_lshlrev_b32 v13, 3, v11
v_add_u32 v13, v13, v12
v_lshrrev_b32 v14, 1, v12
v_and_b32 v15, 1, v11
v_lshlrev_b32 v9, 1, v15
v_or_b32 v14, v14, v9
v_and_b32 v9, 3, v0
v_lshlrev_b32 v9, 3, v9
v_lshlrev_b32 v12, 7, v13
v_add_u32 v12, v12, v9
v_xor_b32 v4, s27, v14
v_lshlrev_b32 v4, 5, v4
v_add_u32 v4, v4, v12
v_add_u32 v4, 16384, v4
v_lshlrev_b32 v5, 2, v11
v_sub_u32 v6, v5, v10
s_mul_i32 s64, s24, 144
s_lshl_b32 s65, s26, 1
s_add_u32 s64, s64, s65
s_lshr_b32 s65, s27, 1
s_add_u32 s64, s64, s65
s_lshl_b32 s74, s64, 12
s_and_b32 s65, s27, 1
s_lshl_b32 s65, s65, 11
s_add_u32 s74, s74, s65
s_add_u32 s75, s74, 294912
s_mov_b32 s76, 0x3eb8aa3b
s_mov_b32 s77, s76
v_lshlrev_b32 v9, 4, v0
s_waitcnt lgkmcnt(0)
v_mov_b32 v1, 0
s_or_b32 s64, s2, s3
s_cmp_lg_u32 s64, 0
s_cbranch_scc1 CS_18
s_memrealtime s[64:65]
s_waitcnt lgkmcnt(0)
s_or_b32 s64, s64, 1
s_xor_b32 s65, s65, 0x5bd1e995
v_mov_b32 v10, s64
v_mov_b32 v11, s65
s_mov_b64 exec, 1
global_store_dwordx2 v1, v[10:11], s[20:21] sc1
s_mov_b64 exec, -1
CS_18:
s_mov_b32 s44, s22
s_mov_b32 s45, s23
s_mov_b32 s46, 14155776
s_mov_b32 s47, 0x20000
s_lshl_b32 s78, s24, 4
s_lshl_b32 s64, s25, 3
s_add_u32 s78, s78, s64
s_add_u32 s78, s78, s26
s_mul_i32 s78, s78, 1152
s_add_u32 s78, s78, 13762560
v_mov_b32 v7, 0xf149f2ca
s_cmp_eq_u32 s24, 0
s_cselect_b32 s64, 0xf149f2ca, 0
v_mov_b32 v8, s64
v_mov_b32 v32, 0
v_mov_b32 v33, 0
v_add_u32 v14, 7, v6
v_cmp_gt_u32 vcc, 8, v14
v_mov_b32 v15, 0xffff
v_add_u32 v14, 0, v6
v_cndmask_b32 v16, v7, v1, vcc
v_cndmask_b32 v15, v1, v15, vcc
v_or_b32 v32, v32, v15
v_cmp_le_i32 vcc, 9, v14
v_add_u32 v15, 0, v5
v_cmp_gt_u32 s[64:65], 8, v15
v_cndmask_b32 v20, v7, v1, vcc
v_cndmask_b32 v24, v7, v8, vcc
v_cmp_le_i32 vcc, 1, v14
s_nop 0
s_and_b64 vcc, vcc, s[64:65]
v_cndmask_b32 v28, v7, v8, vcc
v_add_u32 v14, 8, v6
v_cmp_gt_u32 vcc, 8, v14
v_mov_b32 v15, 0xffff0000
v_add_u32 v14, 1, v6
v_cndmask_b32 v17, v7, v1, vcc
v_cndmask_b32 v15, v1, v15, vcc
v_or_b32 v32, v32, v15
v_cmp_le_i32 vcc, 9, v14
v_add_u32 v15, 1, v5
v_cmp_gt_u32 s[64:65], 8, v15
v_cndmask_b32 v21, v7, v1, vcc
v_cndmask_b32 v25, v7, v8, vcc
v_cmp_le_i32 vcc, 1, v14
s_nop 0
s_and_b64 vcc, vcc, s[64:65]
v_cndmask_b32 v29, v7, v8, vcc
v_add_u32 v14, 9, v6
v_cmp_gt_u32 vcc, 8, v14
v_mov_b32 v15, 0xffff
v_add_u32 v14, 2, v6
v_cndmask_b32 v18, v7, v1, vcc
v_cndmask_b32 v15, v1, v15, vcc
v_or_b32 v33, v33, v15
v_cmp_le_i32 vcc, 9, v14
v_add_u32 v15, 2, v5
v_cmp_gt_u32 s[64:65], 8, v15
v_cndmask_b32 v22, v7, v1, vcc
v_cndmask_b32 v26, v7, v8, vcc
v_cmp_le_i32 vcc, 1, v14
s_nop 0
s_and_b64 vcc, vcc, s[64:65]
v_cndmask_b32 v30, v7, v8, vcc
v_add_u32 v14, 10, v6
v_cmp_gt_u32 vcc, 8, v14
v_mov_b32 v15, 0xffff0000
v_add_u32 v14, 3, v6
v_cndmask_b32 v19, v7, v1, vcc
v_cndmask_b32 v15, v1, v15, vcc
v_or_b32 v33, v33, v15
v_cmp_le_i32 vcc, 9, v14
v_add_u32 v15, 3, v5
v_cmp_gt_u32 s[64:65], 8, v15
v_cndmask_b32 v23, v7, v1, vcc
v_cndmask_b32 v27, v7, v8, vcc
v_cmp_le_i32 vcc, 1, v14
s_nop 0
s_and_b64 vcc, vcc, s[64:65]
v_cndmask_b32 v31, v7, v8, vcc
v_mov_b32 v36, 0
v_mov_b32 v37, 0
v_mov_b32 v38, 0
v_mov_b32 v39, 0
v_mov_b32 v40, 0
v_mov_b32 v41, 0
v_mov_b32 v42, 0
v_mov_b32 v43, 0
v_mov_b32 v44, 0
v_mov_b32 v45, 0
v_mov_b32 v46, 0
v_mov_b32 v47, 0
v_mov_b32 v48, 0
v_mov_b32 v49, 0
v_mov_b32 v50, 0
v_mov_b32 v51, 0
v_mov_b32 v52, 0
v_mov_b32 v53, 0
v_mov_b32 v54, 0
v_mov_b32 v55, 0
v_mov_b32 v56, 0
v_mov_b32 v57, 0
v_mov_b32 v58, 0
v_mov_b32 v59, 0
v_mov_b32 v60, 0
v_mov_b32 v61, 0
v_mov_b32 v62, 0
v_mov_b32 v63, 0
v_mov_b32 v64, 0
v_mov_b32 v65, 0
v_mov_b32 v66, 0
v_mov_b32 v67, 0
v_mov_b32 v68, 0
v_mov_b32 v69, 0
v_mov_b32 v70, 0
v_mov_b32 v71, 0
v_mov_b32 v72, 0
v_mov_b32 v73, 0
v_mov_b32 v74, 0
v_mov_b32 v75, 0
v_mov_b32 v76, 0
v_mov_b32 v77, 0
v_mov_b32 v78, 0
v_mov_b32 v79, 0
v_mov_b32 v80, 0
v_mov_b32 v81, 0
v_mov_b32 v82, 0
v_mov_b32 v83, 0
v_mov_b32 v84, 0
v_mov_b32 v85, 0
v_mov_b32 v86, 0
v_mov_b32 v87, 0
v_mov_b32 v88, 0
v_mov_b32 v89, 0
v_mov_b32 v90, 0
v_mov_b32 v91, 0
v_mov_b32 v92, 0
v_mov_b32 v93, 0
v_mov_b32 v94, 0
v_mov_b32 v95, 0
v_mov_b32 v96, 0
v_mov_b32 v97, 0
v_mov_b32 v98, 0
v_mov_b32 v99, 0
v_mov_b32 v100, 0
v_mov_b32 v101, 0
v_mov_b32 v102, 0
v_mov_b32 v103, 0
v_mov_b32 v104, 0
v_mov_b32 v105, 0
v_mov_b32 v106, 0
v_mov_b32 v107, 0
v_mov_b32 v108, 0
v_mov_b32 v109, 0
v_mov_b32 v110, 0
v_mov_b32 v111, 0
v_mov_b32 v112, 0
v_mov_b32 v113, 0
v_mov_b32 v114, 0
v_mov_b32 v115, 0
v_mov_b32 v116, 0
v_mov_b32 v117, 0
v_mov_b32 v118, 0
v_mov_b32 v119, 0
v_mov_b32 v120, 0
v_mov_b32 v121, 0
v_mov_b32 v122, 0
v_mov_b32 v123, 0
v_mov_b32 v124, 0
v_mov_b32 v125, 0
v_mov_b32 v126, 0
v_mov_b32 v127, 0
v_mov_b32 v128, 0
v_mov_b32 v129, 0
v_mov_b32 v130, 0
v_mov_b32 v131, 0
v_mov_b32 v132, 0
v_mov_b32 v133, 0
v_mov_b32 v134, 0
v_mov_b32 v135, 0
v_mov_b32 v136, 0
v_mov_b32 v137, 0
v_mov_b32 v138, 0
v_mov_b32 v139, 0
s_mov_b32 s66, 0x3f803f80
s_mov_b32 s67, 0xffff0000
s_mov_b32 s70, 1
s_mov_b32 s72, 0
s_mov_b32 s73, 4294922240
s_mov_b32 s79, 90112
v_add_u32 v2, 45056, v2
v_add_u32 v3, 45056, v3
v_add_u32 v4, 45056, v4
s_barrier
ds_read_b128 v[140:143], v2 offset:0
ds_read_b64_tr_b16 v[176:177], v4 offset:0
ds_read_b128 v[144:147], v2 offset:2048
ds_read_b64_tr_b16 v[178:179], v4 offset:512
ds_read_b128 v[148:151], v2 offset:4096
ds_read_b128 v[152:155], v2 offset:6144
ds_read_b64_tr_b16 v[180:181], v4 offset:8192
ds_read_b128 v[156:159], v2 offset:8192
ds_read_b64_tr_b16 v[182:183], v4 offset:8704
ds_read_b128 v[160:163], v2 offset:10240
ds_read_b128 v[164:167], v2 offset:12288
ds_read_b64_tr_b16 v[184:185], v4 offset:16384
ds_read_b128 v[168:171], v2 offset:14336
ds_read_b64_tr_b16 v[186:187], v4 offset:16896
ds_read_b128 v[172:175], v2 offset:40960
.p2align 3
KA_LOOP:
s_waitcnt lgkmcnt(0)
s_add_u32 s70, s70, 1
v_mfma_f32_16x16x32_bf16 v[36:39], v[176:179], v[140:143], v[36:39]
ds_read_b128 v[188:191], v3 offset:0
v_mfma_f32_16x16x32_bf16 v[68:71], v[180:183], v[140:143], v[68:71]
v_mfma_f32_16x16x32_bf16 v[104:107], v[140:143], v[184:187], v[104:107]
ds_read_b64_tr_b16 v[224:225], v4 offset:4096
v_mfma_f32_16x16x32_bf16 v[40:43], v[176:179], v[144:147], v[40:43]
ds_read_b128 v[192:195], v3 offset:2048
v_mfma_f32_16x16x32_bf16 v[72:75], v[180:183], v[144:147], v[72:75]
ds_read_b64_tr_b16 v[226:227], v4 offset:4608
v_mfma_f32_16x16x32_bf16 v[108:111], v[144:147], v[184:187], v[108:111]
v_mfma_f32_16x16x32_bf16 v[44:47], v[176:179], v[148:151], v[44:47]
ds_read_b128 v[196:199], v3 offset:4096
v_mfma_f32_16x16x32_bf16 v[76:79], v[180:183], v[148:151], v[76:79]
ds_read_b128 v[200:203], v3 offset:6144
v_mfma_f32_16x16x32_bf16 v[112:115], v[148:151], v[184:187], v[112:115]
ds_read_b64_tr_b16 v[228:229], v4 offset:12288
v_mfma_f32_16x16x32_bf16 v[48:51], v[176:179], v[152:155], v[48:51]
v_mfma_f32_16x16x32_bf16 v[80:83], v[180:183], v[152:155], v[80:83]
ds_read_b128 v[204:207], v3 offset:8192
v_mfma_f32_16x16x32_bf16 v[116:119], v[152:155], v[184:187], v[116:119]
ds_read_b64_tr_b16 v[230:231], v4 offset:12800
v_mfma_f32_16x16x32_bf16 v[52:55], v[176:179], v[156:159], v[52:55]
ds_read_b128 v[208:211], v3 offset:10240
v_mfma_f32_16x16x32_bf16 v[84:87], v[180:183], v[156:159], v[84:87]
v_mfma_f32_16x16x32_bf16 v[120:123], v[156:159], v[184:187], v[120:123]
ds_read_b128 v[212:215], v3 offset:12288
v_mfma_f32_16x16x32_bf16 v[56:59], v[176:179], v[160:163], v[56:59]
ds_read_b64_tr_b16 v[232:233], v4 offset:20480
v_mfma_f32_16x16x32_bf16 v[88:91], v[180:183], v[160:163], v[88:91]
ds_read_b128 v[216:219], v3 offset:14336
v_mfma_f32_16x16x32_bf16 v[124:127], v[160:163], v[184:187], v[124:127]
v_mfma_f32_16x16x32_bf16 v[60:63], v[176:179], v[164:167], v[60:63]
ds_read_b64_tr_b16 v[234:235], v4 offset:20992
v_mfma_f32_16x16x32_bf16 v[92:95], v[180:183], v[164:167], v[92:95]
ds_read_b128 v[220:223], v3 offset:40960
v_mfma_f32_16x16x32_bf16 v[128:131], v[164:167], v[184:187], v[128:131]
s_cmp_eq_u32 s70, 3
s_cselect_b32 s71, s79, s73
v_mfma_f32_16x16x32_bf16 v[64:67], v[176:179], v[168:171], v[64:67]
s_cselect_b32 s70, 0, s70
s_add_u32 s72, s72, 1
v_mfma_f32_16x16x32_bf16 v[96:99], v[180:183], v[168:171], v[96:99]
s_cmp_eq_u32 s72, s101
s_cbranch_scc1 KA_DUTY
KA_DBACK:
v_mfma_f32_16x16x32_bf16 v[132:135], v[168:171], v[184:187], v[132:135]
s_cmp_eq_u32 s72, 8
s_nop 0
v_mfma_f32_16x16x32_bf16 v[100:103], v[180:183], v[172:175], v[100:103]
v_mfma_f32_16x16x32_bf16 v[136:139], v[172:175], v[184:187], v[136:139]
s_waitcnt lgkmcnt(0)
s_barrier
s_cbranch_scc1 KA_DONE
s_nop 0
v_mfma_f32_16x16x32_bf16 v[36:39], v[224:227], v[188:191], v[36:39]
v_add_u32 v2, s71, v2
v_add_u32 v3, s71, v3
v_mfma_f32_16x16x32_bf16 v[68:71], v[228:231], v[188:191], v[68:71]
v_add_u32 v4, s71, v4
s_nop 0
v_mfma_f32_16x16x32_bf16 v[104:107], v[188:191], v[232:235], v[104:107]
ds_read_b128 v[140:143], v2 offset:0
v_mfma_f32_16x16x32_bf16 v[40:43], v[224:227], v[192:195], v[40:43]
v_mfma_f32_16x16x32_bf16 v[72:75], v[228:231], v[192:195], v[72:75]
ds_read_b64_tr_b16 v[176:177], v4 offset:0
v_mfma_f32_16x16x32_bf16 v[108:111], v[192:195], v[232:235], v[108:111]
ds_read_b128 v[144:147], v2 offset:2048
v_mfma_f32_16x16x32_bf16 v[44:47], v[224:227], v[196:199], v[44:47]
v_mfma_f32_16x16x32_bf16 v[76:79], v[228:231], v[196:199], v[76:79]
ds_read_b64_tr_b16 v[178:179], v4 offset:512
v_mfma_f32_16x16x32_bf16 v[112:115], v[196:199], v[232:235], v[112:115]
ds_read_b128 v[148:151], v2 offset:4096
v_mfma_f32_16x16x32_bf16 v[48:51], v[224:227], v[200:203], v[48:51]
v_mfma_f32_16x16x32_bf16 v[80:83], v[228:231], v[200:203], v[80:83]
ds_read_b128 v[152:155], v2 offset:6144
v_mfma_f32_16x16x32_bf16 v[116:119], v[200:203], v[232:235], v[116:119]
ds_read_b64_tr_b16 v[180:181], v4 offset:8192
v_mfma_f32_16x16x32_bf16 v[52:55], v[224:227], v[204:207], v[52:55]
v_mfma_f32_16x16x32_bf16 v[84:87], v[228:231], v[204:207], v[84:87]
ds_read_b128 v[156:159], v2 offset:8192
v_mfma_f32_16x16x32_bf16 v[120:123], v[204:207], v[232:235], v[120:123]
ds_read_b64_tr_b16 v[182:183], v4 offset:8704
v_mfma_f32_16x16x32_bf16 v[56:59], v[224:227], v[208:211], v[56:59]
v_mfma_f32_16x16x32_bf16 v[88:91], v[228:231], v[208:211], v[88:91]
ds_read_b128 v[160:163], v2 offset:10240
v_mfma_f32_16x16x32_bf16 v[124:127], v[208:211], v[232:235], v[124:127]
ds_read_b128 v[164:167], v2 offset:12288
v_mfma_f32_16x16x32_bf16 v[60:63], v[224:227], v[212:215], v[60:63]
v_mfma_f32_16x16x32_bf16 v[92:95], v[228:231], v[212:215], v[92:95]
ds_read_b64_tr_b16 v[184:185], v4 offset:16384
v_mfma_f32_16x16x32_bf16 v[128:131], v[212:215], v[232:235], v[128:131]
ds_read_b128 v[168:171], v2 offset:14336
v_mfma_f32_16x16x32_bf16 v[64:67], v[224:227], v[216:219], v[64:67]
v_mfma_f32_16x16x32_bf16 v[96:99], v[228:231], v[216:219], v[96:99]
ds_read_b64_tr_b16 v[186:187], v4 offset:16896
v_mfma_f32_16x16x32_bf16 v[132:135], v[216:219], v[232:235], v[132:135]
ds_read_b128 v[172:175], v2 offset:40960
v_mfma_f32_16x16x32_bf16 v[100:103], v[228:231], v[220:223], v[100:103]
v_mfma_f32_16x16x32_bf16 v[136:139], v[220:223], v[232:235], v[136:139]
s_branch KA_LOOP
KA_DUTY:
buffer_load_dword v255, v254, s[48:51], s100 offen
s_branch KA_DBACK
.p2align 3
KA_DONE:
s_setprio 3
s_nop 0
v_mfma_f32_16x16x32_bf16 v[36:39], v[224:227], v[188:191], v[36:39]
v_mov_b32 v184, s66
v_mov_b32 v185, s66
v_mfma_f32_16x16x32_bf16 v[68:71], v[228:231], v[188:191], v[68:71]
v_mov_b32 v186, s66
v_mov_b32 v187, s66
v_mfma_f32_16x16x32_bf16 v[40:43], v[224:227], v[192:195], v[40:43]
global_load_dwordx2 v[10:11], v1, s[20:21] sc1
v_mfma_f32_16x16x32_bf16 v[72:75], v[228:231], v[192:195], v[72:75]
v_cvt_pk_bf16_f32 v140, v36, v37
v_cvt_pk_bf16_f32 v141, v38, v39
v_mfma_f32_16x16x32_bf16 v[44:47], v[224:227], v[196:199], v[44:47]
v_cvt_pk_bf16_f32 v156, v68, v69
v_cvt_pk_bf16_f32 v157, v70, v71
v_mfma_f32_16x16x32_bf16 v[76:79], v[228:231], v[196:199], v[76:79]
v_cvt_pk_bf16_f32 v142, v40, v41
v_cvt_pk_bf16_f32 v143, v42, v43
v_mfma_f32_16x16x32_bf16 v[48:51], v[224:227], v[200:203], v[48:51]
v_cvt_pk_bf16_f32 v158, v72, v73
v_cvt_pk_bf16_f32 v159, v74, v75
v_mfma_f32_16x16x32_bf16 v[80:83], v[228:231], v[200:203], v[80:83]
v_cvt_pk_bf16_f32 v144, v44, v45
v_cvt_pk_bf16_f32 v145, v46, v47
v_mfma_f32_16x16x32_bf16 v[100:103], v[228:231], v[220:223], v[100:103]
v_cvt_pk_bf16_f32 v160, v76, v77
v_cvt_pk_bf16_f32 v161, v78, v79
v_mfma_f32_16x16x32_bf16 v[52:55], v[224:227], v[204:207], v[52:55]
v_cvt_pk_bf16_f32 v146, v48, v49
v_cvt_pk_bf16_f32 v147, v50, v51
v_mfma_f32_16x16x32_bf16 v[84:87], v[228:231], v[204:207], v[84:87]
v_cvt_pk_bf16_f32 v162, v80, v81
v_cvt_pk_bf16_f32 v163, v82, v83
v_mfma_f32_16x16x32_bf16 v[56:59], v[224:227], v[208:211], v[56:59]
v_cvt_pk_bf16_f32 v172, v100, v101
v_cvt_pk_bf16_f32 v173, v102, v103
v_mfma_f32_16x16x32_bf16 v[88:91], v[228:231], v[208:211], v[88:91]
v_cvt_pk_bf16_f32 v148, v52, v53
v_cvt_pk_bf16_f32 v149, v54, v55
v_mfma_f32_16x16x32_bf16 v[60:63], v[224:227], v[212:215], v[60:63]
v_cvt_pk_bf16_f32 v164, v84, v85
v_cvt_pk_bf16_f32 v165, v86, v87
v_mfma_f32_16x16x32_bf16 v[92:95], v[228:231], v[212:215], v[92:95]
v_cvt_pk_bf16_f32 v150, v56, v57
v_cvt_pk_bf16_f32 v151, v58, v59
v_mfma_f32_16x16x32_bf16 v[64:67], v[224:227], v[216:219], v[64:67]
v_cvt_pk_bf16_f32 v166, v88, v89
v_cvt_pk_bf16_f32 v167, v90, v91
v_mfma_f32_16x16x32_bf16 v[96:99], v[228:231], v[216:219], v[96:99]
v_cvt_pk_bf16_f32 v152, v60, v61
v_cvt_pk_bf16_f32 v153, v62, v63
v_mfma_f32_16x16x16_bf16 v[36:39], v[156:157], v[140:141], v[16:19]
v_cvt_pk_bf16_f32 v168, v92, v93
v_cvt_pk_bf16_f32 v169, v94, v95
v_mfma_f32_16x16x16_bf16 v[68:71], v[172:173], v[140:141], v[24:27]
v_cvt_pk_bf16_f32 v154, v64, v65
v_cvt_pk_bf16_f32 v155, v66, v67
v_mfma_f32_16x16x16_bf16 v[40:43], v[158:159], v[142:143], v[16:19]
v_cvt_pk_bf16_f32 v170, v96, v97
v_cvt_pk_bf16_f32 v171, v98, v99
v_mfma_f32_16x16x16_bf16 v[72:75], v[156:157], v[142:143], v[20:23]
v_mfma_f32_16x16x16_bf16 v[44:47], v[160:161], v[144:145], v[16:19]
v_mfma_f32_16x16x16_bf16 v[76:79], v[158:159], v[144:145], v[20:23]
v_max_f32 v36, v36, v68
v_max_f32 v37, v37, v69
v_mfma_f32_16x16x16_bf16 v[48:51], v[162:163], v[146:147], v[16:19]
v_max_f32 v38, v38, v70
v_max_f32 v39, v39, v71
v_mfma_f32_16x16x16_bf16 v[80:83], v[160:161], v[146:147], v[20:23]
v_max_f32 v40, v40, v72
v_max_f32 v41, v41, v73
v_mfma_f32_16x16x16_bf16 v[52:55], v[164:165], v[148:149], v[16:19]
v_max_f32 v44, v44, v76
v_max_f32 v45, v45, v77
v_mfma_f32_16x16x16_bf16 v[84:87], v[172:173], v[148:149], v[28:31]
v_cvt_pk_bf16_f32 v37, v36, v37
v_max_f32 v42, v42, v74
v_mfma_f32_16x16x16_bf16 v[56:59], v[166:167], v[150:151], v[16:19]
v_max_f32 v48, v48, v80
v_max_f32 v49, v49, v81
v_mfma_f32_16x16x16_bf16 v[88:91], v[164:165], v[150:151], v[20:23]
v_max_f32 v43, v43, v75
v_cvt_pk_bf16_f32 v41, v40, v41
v_mfma_f32_16x16x16_bf16 v[60:63], v[168:169], v[152:153], v[16:19]
v_max_f32 v46, v46, v78
v_max_f32 v47, v47, v79
v_mfma_f32_16x16x16_bf16 v[92:95], v[166:167], v[152:153], v[20:23]
v_cvt_pk_bf16_f32 v45, v44, v45
v_max_f32 v50, v50, v82
v_mfma_f32_16x16x16_bf16 v[64:67], v[170:171], v[154:155], v[16:19]
v_max_f32 v51, v51, v83
v_cvt_pk_bf16_f32 v49, v48, v49
v_mfma_f32_16x16x16_bf16 v[96:99], v[168:169], v[154:155], v[20:23]
v_lshlrev_b32 v36, 16, v37
v_cvt_pk_bf16_f32 v39, v38, v39
v_mfma_f32_16x16x32_bf16 v[104:107], v[188:191], v[232:235], v[104:107]
v_lshlrev_b32 v40, 16, v41
v_cvt_pk_bf16_f32 v43, v42, v43
v_mfma_f32_16x16x32_bf16 v[108:111], v[192:195], v[232:235], v[108:111]
v_lshlrev_b32 v44, 16, v45
v_cvt_pk_bf16_f32 v47, v46, v47
v_mfma_f32_16x16x32_bf16 v[136:139], v[220:223], v[232:235], v[136:139]
v_lshlrev_b32 v48, 16, v49
v_cvt_pk_bf16_f32 v51, v50, v51
v_mfma_f32_16x16x32_bf16 v[124:127], v[208:211], v[232:235], v[124:127]
v_and_b32 v37, s67, v37
v_lshlrev_b32 v38, 16, v39
v_mfma_f32_16x16x32_bf16 v[128:131], v[212:215], v[232:235], v[128:131]
v_and_b32 v41, s67, v41
v_lshlrev_b32 v42, 16, v43
v_mfma_f32_16x16x32_bf16 v[112:115], v[196:199], v[232:235], v[112:115]
v_and_b32 v45, s67, v45
v_lshlrev_b32 v46, 16, v47
v_mfma_f32_16x16x32_bf16 v[116:119], v[200:203], v[232:235], v[116:119]
v_and_b32 v49, s67, v49
v_lshlrev_b32 v50, 16, v51
v_mfma_f32_16x16x32_bf16 v[132:135], v[216:219], v[232:235], v[132:135]
v_and_b32 v39, s67, v39
v_max3_f32 v174, v36, v37, v38
v_mfma_f32_16x16x32_bf16 v[120:123], v[204:207], v[232:235], v[120:123]
v_and_b32 v43, s67, v43
v_max3_f32 v175, v40, v41, v42
v_and_b32 v47, s67, v47
v_max3_f32 v176, v44, v45, v46
v_and_b32 v51, s67, v51
v_max3_f32 v177, v48, v49, v50
v_max_f32 v174, v174, v39
v_max_f32 v175, v175, v43
v_max_f32 v176, v176, v47
v_max_f32 v177, v177, v51
v_max_f32 v52, v52, v84
v_max_f32 v53, v53, v85
v_max_f32 v56, v56, v88
v_max_f32 v57, v57, v89
v_max_f32 v60, v60, v92
v_max_f32 v61, v61, v93
v_max_f32 v64, v64, v96
v_max_f32 v65, v65, v97
v_permlane32_swap_b32 v174, v175
v_permlane32_swap_b32 v176, v177
v_max_f32 v54, v54, v86
v_max_f32 v55, v55, v87
v_cvt_pk_bf16_f32 v53, v52, v53
v_max_f32 v58, v58, v90
v_max_f32 v59, v59, v91
v_cvt_pk_bf16_f32 v57, v56, v57
v_max_f32 v62, v62, v94
v_max_f32 v63, v63, v95
v_cvt_pk_bf16_f32 v61, v60, v61
v_max_f32 v66, v66, v98
v_max_f32 v67, v67, v99
v_cvt_pk_bf16_f32 v65, v64, v65
v_max_f32 v174, v174, v175
v_max_f32 v176, v176, v177
v_lshlrev_b32 v52, 16, v53
v_cvt_pk_bf16_f32 v55, v54, v55
v_lshlrev_b32 v56, 16, v57
v_cvt_pk_bf16_f32 v59, v58, v59
v_lshlrev_b32 v60, 16, v61
v_cvt_pk_bf16_f32 v63, v62, v63
v_lshlrev_b32 v64, 16, v65
v_cvt_pk_bf16_f32 v67, v66, v67
v_and_b32 v53, s67, v53
v_lshlrev_b32 v54, 16, v55
v_and_b32 v57, s67, v57
v_lshlrev_b32 v58, 16, v59
v_and_b32 v61, s67, v61
v_lshlrev_b32 v62, 16, v63
v_and_b32 v65, s67, v65
v_lshlrev_b32 v66, 16, v67
v_and_b32 v55, s67, v55
v_max3_f32 v178, v52, v53, v54
v_and_b32 v59, s67, v59
v_max3_f32 v179, v56, v57, v58
v_and_b32 v63, s67, v63
v_max3_f32 v180, v60, v61, v62
v_and_b32 v67, s67, v67
v_max3_f32 v181, v64, v65, v66
v_permlane16_swap_b32 v174, v176
v_max_f32 v178, v178, v55
v_max_f32 v179, v179, v59
v_max_f32 v180, v180, v63
v_max_f32 v181, v181, v67
v_max_f32 v174, v174, v176
v_mul_f32 v68, s76, v174
v_mul_f32 v76, s76, v174
v_permlane32_swap_b32 v178, v179
v_permlane32_swap_b32 v180, v181
v_permlane16_swap_b32 v68, v76
v_max_f32 v178, v178, v179
v_max_f32 v180, v180, v181
v_mov_b32 v72, v68
v_mov_b32 v80, v76
v_permlane16_swap_b32 v178, v180
v_permlane32_swap_b32 v68, v72
v_max_f32 v178, v178, v180
v_mul_f32 v84, s76, v178
v_mul_f32 v92, s76, v178
v_pk_fma_f32 v[36:37], v[36:37], s[76:77], v[68:69] op_sel_hi:[1,1,0] neg_lo:[0,0,1] neg_hi:[0,0,1]
v_pk_fma_f32 v[38:39], v[38:39], s[76:77], v[68:69] op_sel_hi:[1,1,0] neg_lo:[0,0,1] neg_hi:[0,0,1]
v_pk_fma_f32 v[40:41], v[40:41], s[76:77], v[72:73] op_sel_hi:[1,1,0] neg_lo:[0,0,1] neg_hi:[0,0,1]
v_pk_fma_f32 v[42:43], v[42:43], s[76:77], v[72:73] op_sel_hi:[1,1,0] neg_lo:[0,0,1] neg_hi:[0,0,1]
v_exp_f32 v36, v36
v_exp_f32 v37, v37
v_exp_f32 v38, v38
v_exp_f32 v39, v39
v_exp_f32 v40, v40
v_exp_f32 v41, v41
v_exp_f32 v42, v42
v_exp_f32 v43, v43
v_permlane32_swap_b32 v76, v80
v_permlane16_swap_b32 v84, v92
v_mov_b32 v88, v84
v_cvt_pk_bf16_f32 v210, v36, v37
v_cvt_pk_bf16_f32 v211, v38, v39
v_cvt_pk_bf16_f32 v214, v40, v41
v_cvt_pk_bf16_f32 v215, v42, v43
v_pk_fma_f32 v[44:45], v[44:45], s[76:77], v[76:77] op_sel_hi:[1,1,0] neg_lo:[0,0,1] neg_hi:[0,0,1]
v_pk_fma_f32 v[46:47], v[46:47], s[76:77], v[76:77] op_sel_hi:[1,1,0] neg_lo:[0,0,1] neg_hi:[0,0,1]
v_pk_fma_f32 v[48:49], v[48:49], s[76:77], v[80:81] op_sel_hi:[1,1,0] neg_lo:[0,0,1] neg_hi:[0,0,1]
v_pk_fma_f32 v[50:51], v[50:51], s[76:77], v[80:81] op_sel_hi:[1,1,0] neg_lo:[0,0,1] neg_hi:[0,0,1]
v_bfi_b32 v208, v32, 0, v210
v_bfi_b32 v209, v33, 0, v211
v_bfi_b32 v212, v32, 0, v214
v_bfi_b32 v213, v33, 0, v215
v_exp_f32 v44, v44
v_exp_f32 v45, v45
v_exp_f32 v46, v46
v_exp_f32 v47, v47
v_exp_f32 v48, v48
v_exp_f32 v49, v49
v_exp_f32 v50, v50
v_exp_f32 v51, v51
v_and_b32 v210, v32, v210
v_and_b32 v211, v33, v211
v_and_b32 v214, v32, v214
v_and_b32 v215, v33, v215
v_mfma_f32_16x16x32_bf16 v[68:71], v[184:187], v[208:211], 0
v_permlane32_swap_b32 v84, v88
v_mov_b32 v96, v92
v_mfma_f32_16x16x32_bf16 v[72:75], v[184:187], v[212:215], 0
v_cvt_pk_bf16_f32 v218, v44, v45
v_cvt_pk_bf16_f32 v219, v46, v47
v_cvt_pk_bf16_f32 v222, v48, v49
v_cvt_pk_bf16_f32 v223, v50, v51
v_pk_fma_f32 v[52:53], v[52:53], s[76:77], v[84:85] op_sel_hi:[1,1,0] neg_lo:[0,0,1] neg_hi:[0,0,1]
v_pk_fma_f32 v[54:55], v[54:55], s[76:77], v[84:85] op_sel_hi:[1,1,0] neg_lo:[0,0,1] neg_hi:[0,0,1]
v_pk_fma_f32 v[56:57], v[56:57], s[76:77], v[88:89] op_sel_hi:[1,1,0] neg_lo:[0,0,1] neg_hi:[0,0,1]
v_pk_fma_f32 v[58:59], v[58:59], s[76:77], v[88:89] op_sel_hi:[1,1,0] neg_lo:[0,0,1] neg_hi:[0,0,1]
v_cvt_pk_bf16_f32 v190, v104, v105
v_cvt_pk_bf16_f32 v191, v106, v107
v_cvt_pk_bf16_f32 v192, v108, v109
v_cvt_pk_bf16_f32 v193, v110, v111
v_cvt_pk_bf16_f32 v188, v136, v137
v_cvt_pk_bf16_f32 v189, v138, v139
v_mfma_f32_16x16x32_bf16 v[40:43], v[190:193], v[212:215], 0
v_bfi_b32 v216, v32, 0, v218
v_bfi_b32 v217, v33, 0, v219
v_mfma_f32_16x16x32_bf16 v[36:39], v[188:191], v[208:211], 0
v_bfi_b32 v220, v32, 0, v222
v_bfi_b32 v221, v33, 0, v223
v_exp_f32 v52, v52
v_exp_f32 v53, v53
v_exp_f32 v54, v54
v_exp_f32 v55, v55
v_exp_f32 v56, v56
v_exp_f32 v57, v57
v_exp_f32 v58, v58
v_exp_f32 v59, v59
v_and_b32 v218, v32, v218
v_and_b32 v219, v33, v219
v_and_b32 v222, v32, v222
v_and_b32 v223, v33, v223
v_mfma_f32_16x16x32_bf16 v[76:79], v[184:187], v[216:219], 0
v_permlane32_swap_b32 v92, v96
v_cvt_pk_bf16_f32 v226, v52, v53
v_mfma_f32_16x16x32_bf16 v[80:83], v[184:187], v[220:223], 0
v_cvt_pk_bf16_f32 v227, v54, v55
v_cvt_pk_bf16_f32 v230, v56, v57
v_cvt_pk_bf16_f32 v231, v58, v59
v_pk_fma_f32 v[60:61], v[60:61], s[76:77], v[92:93] op_sel_hi:[1,1,0] neg_lo:[0,0,1] neg_hi:[0,0,1]
v_pk_fma_f32 v[62:63], v[62:63], s[76:77], v[92:93] op_sel_hi:[1,1,0] neg_lo:[0,0,1] neg_hi:[0,0,1]
v_pk_fma_f32 v[64:65], v[64:65], s[76:77], v[96:97] op_sel_hi:[1,1,0] neg_lo:[0,0,1] neg_hi:[0,0,1]
v_pk_fma_f32 v[66:67], v[66:67], s[76:77], v[96:97] op_sel_hi:[1,1,0] neg_lo:[0,0,1] neg_hi:[0,0,1]
v_cvt_pk_bf16_f32 v194, v112, v113
v_cvt_pk_bf16_f32 v195, v114, v115
v_cvt_pk_bf16_f32 v196, v116, v117
v_cvt_pk_bf16_f32 v197, v118, v119
v_mfma_f32_16x16x32_bf16 v[44:47], v[192:195], v[216:219], 0
v_bfi_b32 v224, v32, 0, v226
v_bfi_b32 v225, v33, 0, v227
v_mfma_f32_16x16x32_bf16 v[48:51], v[194:197], v[220:223], 0
v_bfi_b32 v228, v32, 0, v230
v_bfi_b32 v229, v33, 0, v231
v_exp_f32 v60, v60
v_exp_f32 v61, v61
v_exp_f32 v62, v62
v_exp_f32 v63, v63
v_exp_f32 v64, v64
v_exp_f32 v65, v65
v_exp_f32 v66, v66
v_exp_f32 v67, v67
v_and_b32 v226, v32, v226
v_and_b32 v227, v33, v227
v_and_b32 v230, v32, v230
v_and_b32 v231, v33, v231
v_mfma_f32_16x16x32_bf16 v[84:87], v[184:187], v[224:227], 0
v_cvt_pk_bf16_f32 v234, v60, v61
v_cvt_pk_bf16_f32 v235, v62, v63
v_mfma_f32_16x16x32_bf16 v[88:91], v[184:187], v[228:231], 0
v_cvt_pk_bf16_f32 v238, v64, v65
v_cvt_pk_bf16_f32 v239, v66, v67
v_cvt_pk_bf16_f32 v200, v120, v121
v_cvt_pk_bf16_f32 v201, v122, v123
v_cvt_pk_bf16_f32 v202, v124, v125
v_cvt_pk_bf16_f32 v203, v126, v127
v_cvt_pk_bf16_f32 v198, v136, v137
v_cvt_pk_bf16_f32 v199, v138, v139
v_mfma_f32_16x16x32_bf16 v[56:59], v[200:203], v[228:231], 0
v_bfi_b32 v232, v32, 0, v234
v_bfi_b32 v233, v33, 0, v235
v_mfma_f32_16x16x32_bf16 v[52:55], v[198:201], v[224:227], 0
v_bfi_b32 v236, v32, 0, v238
v_bfi_b32 v237, v33, 0, v239
v_and_b32 v234, v32, v234
v_and_b32 v235, v33, v235
v_and_b32 v238, v32, v238
v_and_b32 v239, v33, v239
v_mfma_f32_16x16x32_bf16 v[92:95], v[184:187], v[232:235], 0
v_rcp_f32 v68, v68
v_mfma_f32_16x16x32_bf16 v[96:99], v[184:187], v[236:239], 0
v_rcp_f32 v72, v72
v_cvt_pk_bf16_f32 v204, v128, v129
v_cvt_pk_bf16_f32 v205, v130, v131
v_cvt_pk_bf16_f32 v206, v132, v133
v_cvt_pk_bf16_f32 v207, v134, v135
v_mfma_f32_16x16x32_bf16 v[60:63], v[202:205], v[232:235], 0
v_pk_mul_f32 v[36:37], v[36:37], v[68:69] op_sel_hi:[1,0]
v_pk_mul_f32 v[38:39], v[38:39], v[68:69] op_sel_hi:[1,0]
v_mfma_f32_16x16x32_bf16 v[64:67], v[204:207], v[236:239], 0
v_pk_mul_f32 v[40:41], v[40:41], v[72:73] op_sel_hi:[1,0]
v_pk_mul_f32 v[42:43], v[42:43], v[72:73] op_sel_hi:[1,0]
v_cvt_pk_bf16_f32 v140, v36, v37
v_cvt_pk_bf16_f32 v141, v38, v39
v_cvt_pk_bf16_f32 v142, v40, v41
v_cvt_pk_bf16_f32 v143, v42, v43
v_rcp_f32 v76, v76
v_rcp_f32 v80, v80
v_permlane16_swap_b32 v140, v142
v_permlane16_swap_b32 v141, v143
v_pk_mul_f32 v[44:45], v[44:45], v[76:77] op_sel_hi:[1,0]
v_pk_mul_f32 v[46:47], v[46:47], v[76:77] op_sel_hi:[1,0]
v_pk_mul_f32 v[48:49], v[48:49], v[80:81] op_sel_hi:[1,0]
v_pk_mul_f32 v[50:51], v[50:51], v[80:81] op_sel_hi:[1,0]
buffer_store_dwordx4 v[140:143], v9, s[44:47], s74 offen offset:0 sc1
v_cvt_pk_bf16_f32 v144, v44, v45
v_cvt_pk_bf16_f32 v145, v46, v47
v_cvt_pk_bf16_f32 v146, v48, v49
v_cvt_pk_bf16_f32 v147, v50, v51
v_rcp_f32 v84, v84
v_rcp_f32 v88, v88
v_permlane16_swap_b32 v144, v146
v_permlane16_swap_b32 v145, v147
v_pk_mul_f32 v[52:53], v[52:53], v[84:85] op_sel_hi:[1,0]
v_pk_mul_f32 v[54:55], v[54:55], v[84:85] op_sel_hi:[1,0]
v_pk_mul_f32 v[56:57], v[56:57], v[88:89] op_sel_hi:[1,0]
v_pk_mul_f32 v[58:59], v[58:59], v[88:89] op_sel_hi:[1,0]
buffer_store_dwordx4 v[144:147], v9, s[44:47], s74 offen offset:1024 sc1
v_cvt_pk_bf16_f32 v148, v52, v53
v_cvt_pk_bf16_f32 v149, v54, v55
v_cvt_pk_bf16_f32 v150, v56, v57
v_cvt_pk_bf16_f32 v151, v58, v59
v_rcp_f32 v92, v92
v_rcp_f32 v96, v96
v_permlane16_swap_b32 v148, v150
v_permlane16_swap_b32 v149, v151
v_pk_mul_f32 v[60:61], v[60:61], v[92:93] op_sel_hi:[1,0]
v_pk_mul_f32 v[62:63], v[62:63], v[92:93] op_sel_hi:[1,0]
v_pk_mul_f32 v[64:65], v[64:65], v[96:97] op_sel_hi:[1,0]
v_pk_mul_f32 v[66:67], v[66:67], v[96:97] op_sel_hi:[1,0]
buffer_store_dwordx4 v[148:151], v9, s[44:47], s75 offen offset:0 sc1
v_cvt_pk_bf16_f32 v152, v60, v61
v_cvt_pk_bf16_f32 v153, v62, v63
v_cvt_pk_bf16_f32 v154, v64, v65
v_cvt_pk_bf16_f32 v155, v66, v67
s_nop 0
v_permlane16_swap_b32 v152, v154
v_permlane16_swap_b32 v153, v155
buffer_store_dwordx4 v[152:155], v9, s[44:47], s75 offen offset:1024 sc1
s_mov_b64 exec, 1
v_mov_b32 v12, 159744
v_mov_b32 v13, 1
s_waitcnt vmcnt(4)
s_mov_b32 s64, 0x40000
TAGL_20:
v_readfirstlane_b32 s30, v10
v_readfirstlane_b32 s31, v11
s_nop 0
s_cmp_lg_u32 s30, 0
s_cbranch_scc1 TAGD_21
s_sub_u32 s64, s64, 1
s_cmp_eq_u32 s64, 0
s_cbranch_scc1 TAGD_21
s_sleep 2
global_load_dwordx2 v[10:11], v1, s[20:21] sc1
s_waitcnt vmcnt(0)
s_branch TAGL_20
TAGD_21:
s_waitcnt vmcnt(0)
ds_add_rtn_u32 v13, v12, v13
s_waitcnt lgkmcnt(0)
v_cmp_eq_u32 vcc, 3, v13
s_nop 0
s_cbranch_vccz NOPUB_19
buffer_store_dwordx2 v[10:11], v1, s[44:47], s78 offen sc1
NOPUB_19:
s_barrier
s_mov_b64 exec, -1
s_mov_b32 s32, s4
s_mov_b32 s33, s5
s_mov_b32 s34, 2097152
s_mov_b32 s35, 0x20000
s_lshl_b32 s64, s24, 7
s_and_b32 s65, s26, 3
s_lshl_b32 s65, s65, 5
s_add_u32 s65, s65, s64
s_lshl_b32 s66, s27, 3
s_add_u32 s65, s65, s66
s_lshr_b32 s66, s26, 2
s_add_u32 s65, s65, s66
s_lshl_b32 s65, s65, 10
s_lshl_b32 s66, s26, 4
s_add_u32 s64, s64, s66
s_lshl_b32 s66, s27, 2
s_add_u32 s64, s64, s66
s_lshl_b32 s78, s64, 3
s_add_u32 s78, s78, 13631488
global_load_dwordx4 v[32:35], v9, s[16:17]
buffer_load_dwordx4 v[16:19], v9, s[32:35], s65 offen
buffer_load_dwordx4 v[20:23], v9, s[32:35], s65 offen offset:2048
s_add_u32 s65, s65, 4096
buffer_load_dwordx4 v[24:27], v9, s[32:35], s65 offen
buffer_load_dwordx4 v[28:31], v9, s[32:35], s65 offen offset:2048
s_waitcnt vmcnt(0)
v_lshlrev_b32 v36, 16, v32
v_and_b32 v37, 0xffff0000, v32
v_lshlrev_b32 v38, 16, v33
v_and_b32 v39, 0xffff0000, v33
v_lshlrev_b32 v40, 16, v34
v_and_b32 v41, 0xffff0000, v34
v_lshlrev_b32 v42, 16, v35
v_and_b32 v43, 0xffff0000, v35
v_lshlrev_b32 v44, 16, v16
v_and_b32 v45, 0xffff0000, v16
v_lshlrev_b32 v46, 16, v17
v_and_b32 v47, 0xffff0000, v17
v_lshlrev_b32 v48, 16, v18
v_and_b32 v49, 0xffff0000, v18
v_lshlrev_b32 v50, 16, v19
v_and_b32 v51, 0xffff0000, v19
v_pk_mul_f32 v[44:45], v[44:45], v[36:37]
v_pk_mul_f32 v[46:47], v[46:47], v[38:39]
v_pk_mul_f32 v[48:49], v[48:49], v[40:41]
v_pk_mul_f32 v[50:51], v[50:51], v[42:43]
v_cvt_pk_bf16_f32 v16, v44, v45
v_cvt_pk_bf16_f32 v17, v46, v47
v_cvt_pk_bf16_f32 v18, v48, v49
v_cvt_pk_bf16_f32 v19, v50, v51
v_lshlrev_b32 v44, 16, v16
v_and_b32 v45, 0xffff0000, v16
v_lshlrev_b32 v46, 16, v17
v_and_b32 v47, 0xffff0000, v17
v_lshlrev_b32 v48, 16, v18
v_and_b32 v49, 0xffff0000, v18
v_lshlrev_b32 v50, 16, v19
v_and_b32 v51, 0xffff0000, v19
v_pk_add_f32 v[44:45], v[44:45], v[48:49]
v_pk_add_f32 v[46:47], v[46:47], v[50:51]
v_pk_add_f32 v[44:45], v[44:45], v[46:47]
v_add_f32 v52, v44, v45
v_lshlrev_b32 v44, 16, v20
v_and_b32 v45, 0xffff0000, v20
v_lshlrev_b32 v46, 16, v21
v_and_b32 v47, 0xffff0000, v21
v_lshlrev_b32 v48, 16, v22
v_and_b32 v49, 0xffff0000, v22
v_lshlrev_b32 v50, 16, v23
v_and_b32 v51, 0xffff0000, v23
v_pk_mul_f32 v[44:45], v[44:45], v[36:37]
v_pk_mul_f32 v[46:47], v[46:47], v[38:39]
v_pk_mul_f32 v[48:49], v[48:49], v[40:41]
v_pk_mul_f32 v[50:51], v[50:51], v[42:43]
v_cvt_pk_bf16_f32 v20, v44, v45
v_cvt_pk_bf16_f32 v21, v46, v47
v_cvt_pk_bf16_f32 v22, v48, v49
v_cvt_pk_bf16_f32 v23, v50, v51
v_lshlrev_b32 v44, 16, v20
v_and_b32 v45, 0xffff0000, v20
v_lshlrev_b32 v46, 16, v21
v_and_b32 v47, 0xffff0000, v21
v_lshlrev_b32 v48, 16, v22
v_and_b32 v49, 0xffff0000, v22
v_lshlrev_b32 v50, 16, v23
v_and_b32 v51, 0xffff0000, v23
v_pk_add_f32 v[44:45], v[44:45], v[48:49]
v_pk_add_f32 v[46:47], v[46:47], v[50:51]
v_pk_add_f32 v[44:45], v[44:45], v[46:47]
v_add_f32 v53, v44, v45
v_lshlrev_b32 v44, 16, v24
v_and_b32 v45, 0xffff0000, v24
v_lshlrev_b32 v46, 16, v25
v_and_b32 v47, 0xffff0000, v25
v_lshlrev_b32 v48, 16, v26
v_and_b32 v49, 0xffff0000, v26
v_lshlrev_b32 v50, 16, v27
v_and_b32 v51, 0xffff0000, v27
v_pk_mul_f32 v[44:45], v[44:45], v[36:37]
v_pk_mul_f32 v[46:47], v[46:47], v[38:39]
v_pk_mul_f32 v[48:49], v[48:49], v[40:41]
v_pk_mul_f32 v[50:51], v[50:51], v[42:43]
v_cvt_pk_bf16_f32 v24, v44, v45
v_cvt_pk_bf16_f32 v25, v46, v47
v_cvt_pk_bf16_f32 v26, v48, v49
v_cvt_pk_bf16_f32 v27, v50, v51
v_lshlrev_b32 v44, 16, v24
v_and_b32 v45, 0xffff0000, v24
v_lshlrev_b32 v46, 16, v25
v_and_b32 v47, 0xffff0000, v25
v_lshlrev_b32 v48, 16, v26
v_and_b32 v49, 0xffff0000, v26
v_lshlrev_b32 v50, 16, v27
v_and_b32 v51, 0xffff0000, v27
v_pk_add_f32 v[44:45], v[44:45], v[48:49]
v_pk_add_f32 v[46:47], v[46:47], v[50:51]
v_pk_add_f32 v[44:45], v[44:45], v[46:47]
v_add_f32 v54, v44, v45
v_lshlrev_b32 v44, 16, v28
v_and_b32 v45, 0xffff0000, v28
v_lshlrev_b32 v46, 16, v29
v_and_b32 v47, 0xffff0000, v29
v_lshlrev_b32 v48, 16, v30
v_and_b32 v49, 0xffff0000, v30
v_lshlrev_b32 v50, 16, v31
v_and_b32 v51, 0xffff0000, v31
v_pk_mul_f32 v[44:45], v[44:45], v[36:37]
v_pk_mul_f32 v[46:47], v[46:47], v[38:39]
v_pk_mul_f32 v[48:49], v[48:49], v[40:41]
v_pk_mul_f32 v[50:51], v[50:51], v[42:43]
v_cvt_pk_bf16_f32 v28, v44, v45
v_cvt_pk_bf16_f32 v29, v46, v47
v_cvt_pk_bf16_f32 v30, v48, v49
v_cvt_pk_bf16_f32 v31, v50, v51
v_lshlrev_b32 v44, 16, v28
v_and_b32 v45, 0xffff0000, v28
v_lshlrev_b32 v46, 16, v29
v_and_b32 v47, 0xffff0000, v29
v_lshlrev_b32 v48, 16, v30
v_and_b32 v49, 0xffff0000, v30
v_lshlrev_b32 v50, 16, v31
v_and_b32 v51, 0xffff0000, v31
v_pk_add_f32 v[44:45], v[44:45], v[48:49]
v_pk_add_f32 v[46:47], v[46:47], v[50:51]
v_pk_add_f32 v[44:45], v[44:45], v[46:47]
v_add_f32 v55, v44, v45
s_nop 0
v_add_f32_dpp v52, v52, v52 row_ror:8 row_mask:0xf bank_mask:0xf
v_add_f32_dpp v53, v53, v53 row_ror:8 row_mask:0xf bank_mask:0xf
v_add_f32_dpp v54, v54, v54 row_ror:8 row_mask:0xf bank_mask:0xf
v_add_f32_dpp v55, v55, v55 row_ror:8 row_mask:0xf bank_mask:0xf
v_add_f32_dpp v52, v52, v52 row_ror:4 row_mask:0xf bank_mask:0xf
v_add_f32_dpp v53, v53, v53 row_ror:4 row_mask:0xf bank_mask:0xf
v_add_f32_dpp v54, v54, v54 row_ror:4 row_mask:0xf bank_mask:0xf
v_add_f32_dpp v55, v55, v55 row_ror:4 row_mask:0xf bank_mask:0xf
v_add_f32_dpp v52, v52, v52 row_ror:2 row_mask:0xf bank_mask:0xf
v_add_f32_dpp v53, v53, v53 row_ror:2 row_mask:0xf bank_mask:0xf
v_add_f32_dpp v54, v54, v54 row_ror:2 row_mask:0xf bank_mask:0xf
v_add_f32_dpp v55, v55, v55 row_ror:2 row_mask:0xf bank_mask:0xf
v_add_f32_dpp v52, v52, v52 row_ror:1 row_mask:0xf bank_mask:0xf
v_add_f32_dpp v53, v53, v53 row_ror:1 row_mask:0xf bank_mask:0xf
v_add_f32_dpp v54, v54, v54 row_ror:1 row_mask:0xf bank_mask:0xf
v_add_f32_dpp v55, v55, v55 row_ror:1 row_mask:0xf bank_mask:0xf
v_mov_b32 v44, v52
v_mov_b32 v45, v53
v_mov_b32 v46, v54
v_mov_b32 v47, v55
v_permlane32_swap_b32 v52, v44
v_permlane32_swap_b32 v53, v45
v_permlane32_swap_b32 v54, v46
v_permlane32_swap_b32 v55, v47
v_add_f32 v52, v52, v44
v_add_f32 v53, v53, v45
v_add_f32 v54, v54, v46
v_add_f32 v55, v55, v47
v_mov_b32 v44, v52
v_mov_b32 v45, v53
v_mov_b32 v46, v54
v_mov_b32 v47, v55
v_permlane16_swap_b32 v52, v44
v_permlane16_swap_b32 v53, v45
v_permlane16_swap_b32 v54, v46
v_permlane16_swap_b32 v55, v47
v_add_f32 v52, v52, v44
v_add_f32 v53, v53, v45
v_add_f32 v54, v54, v46
v_add_f32 v55, v55, v47
v_cvt_pk_bf16_f32 v44, v52, v53
v_cvt_pk_bf16_f32 v45, v54, v55
v_lshlrev_b32 v52, 16, v44
v_and_b32 v53, 0xffff0000, v44
v_lshlrev_b32 v54, 16, v45
v_and_b32 v55, 0xffff0000, v45
v_mul_f32 v52, 0xbfb8aa3b, v52
v_mul_f32 v53, 0xbfb8aa3b, v53
v_mul_f32 v54, 0xbfb8aa3b, v54
v_mul_f32 v55, 0xbfb8aa3b, v55
v_exp_f32 v52, v52
v_exp_f32 v53, v53
v_exp_f32 v54, v54
v_exp_f32 v55, v55
v_add_f32 v52, 1.0, v52
v_add_f32 v53, 1.0, v53
v_add_f32 v54, 1.0, v54
v_add_f32 v55, 1.0, v55
v_rcp_f32 v52, v52
v_rcp_f32 v53, v53
v_rcp_f32 v54, v54
v_rcp_f32 v55, v55
s_nop 0
v_cvt_pk_bf16_f32 v44, v52, v53
v_cvt_pk_bf16_f32 v45, v54, v55
v_lshlrev_b32 v52, 16, v44
v_and_b32 v53, 0xffff0000, v44
v_lshlrev_b32 v54, 16, v45
v_and_b32 v55, 0xffff0000, v45
v_cmp_eq_u32 vcc, 1, v0
v_mov_b32 v46, s30
v_mov_b32 v47, s31
v_cndmask_b32 v44, v52, v54, vcc
v_cndmask_b32 v45, v53, v55, vcc
s_mov_b64 exec, 3
buffer_store_dwordx4 v[44:47], v9, s[44:47], s78 offen sc1
s_mov_b64 exec, -1
K_CFIN:
s_mov_b64 exec, -1
s_setprio 0
s_and_b32 s64, s2, 1
s_lshl_b32 s28, s24, 1
s_add_u32 s28, s28, s64
s_and_b32 s64, s2, 2
s_lshl_b32 s64, s64, 1
s_lshr_b32 s65, s2, 6
s_add_u32 s65, s65, s24
s_and_b32 s65, s65, 3
s_add_u32 s29, s64, s65
s_mov_b32 s52, s18
s_mov_b32 s53, s19
s_mov_b32 s54, 2097152
s_mov_b32 s55, 0x20000
s_lshr_b32 s64, s28, 1
s_lshl_b32 s64, s64, 7
s_lshl_b32 s65, s27, 5
s_add_u32 s64, s64, s65
s_and_b32 s65, s28, 1
s_add_u32 s64, s64, s65
s_lshl_b32 s64, s64, 10
s_lshl_b32 s65, s29, 7
s_add_u32 s70, s64, s65
s_add_u32 s70, s70, 16384
s_lshl_b32 s73, s27, 14
s_sub_u32 s73, 133120, s73
v_lshrrev_b32 v93, 3, v0
v_and_b32 v94, 7, v0
v_lshlrev_b32 v92, 11, v93
v_lshlrev_b32 v95, 4, v94
v_add_u32 v92, v92, v95
v_lshlrev_b32 v95, 1, v94
v_xor_b32 v95, v95, v93
v_lshlrev_b32 v95, 4, v95
v_lshlrev_b32 v93, 8, v93
v_add_u32 v95, v95, v93
v_add_u32 v95, s73, v95
v_xor_b32 v88, 128, v95
v_xor_b32 v89, 144, v95
s_lshl_b32 s72, s27, 9
s_add_u32 s72, s72, 160768
v_lshlrev_b32 v103, 3, v0
v_add_u32 v103, s72, v103
s_barrier
ds_read_b64 v[96:97], v103
ds_read_b128 v[104:107], v88 offset:12288
ds_read_b128 v[108:111], v89 offset:12288
ds_read_b128 v[112:115], v88 offset:24576
ds_read_b128 v[116:119], v89 offset:24576
ds_read_b128 v[120:123], v88 offset:20480
ds_read_b128 v[124:127], v89 offset:20480
ds_read_b128 v[128:131], v88 offset:16384
ds_read_b128 v[132:135], v89 offset:16384
s_waitcnt lgkmcnt(6)
v_pk_mul_f32 v[104:105], v[104:105], v[96:97] op_sel_hi:[1,0]
v_pk_mul_f32 v[106:107], v[106:107], v[96:97] op_sel_hi:[1,0]
v_pk_mul_f32 v[108:109], v[108:109], v[96:97] op_sel_hi:[1,0]
v_pk_mul_f32 v[110:111], v[110:111], v[96:97] op_sel_hi:[1,0]
s_waitcnt lgkmcnt(2)
v_pk_add_f32 v[112:113], v[112:113], v[120:121]
v_pk_add_f32 v[114:115], v[114:115], v[122:123]
v_pk_add_f32 v[116:117], v[116:117], v[124:125]
v_pk_add_f32 v[118:119], v[118:119], v[126:127]
s_waitcnt lgkmcnt(0)
v_pk_add_f32 v[112:113], v[112:113], v[128:129]
v_pk_add_f32 v[114:115], v[114:115], v[130:131]
v_pk_add_f32 v[116:117], v[116:117], v[132:133]
v_pk_add_f32 v[118:119], v[118:119], v[134:135]
v_pk_fma_f32 v[104:105], v[112:113], v[96:97], v[104:105] op_sel:[0,1,0] op_sel_hi:[1,1,1]
v_pk_fma_f32 v[106:107], v[114:115], v[96:97], v[106:107] op_sel:[0,1,0] op_sel_hi:[1,1,1]
v_pk_fma_f32 v[108:109], v[116:117], v[96:97], v[108:109] op_sel:[0,1,0] op_sel_hi:[1,1,1]
v_pk_fma_f32 v[110:111], v[118:119], v[96:97], v[110:111] op_sel:[0,1,0] op_sel_hi:[1,1,1]
v_cvt_pk_bf16_f32 v120, v104, v105
v_cvt_pk_bf16_f32 v121, v106, v107
v_cvt_pk_bf16_f32 v122, v108, v109
v_cvt_pk_bf16_f32 v123, v110, v111
buffer_store_dwordx4 v[120:123], v92, s[52:55], s70 offen sc1
s_endpgm
K_CODE_END:
.section .rodata,"a"
.p2align 6
.amdhsa_kernel gated_mix__sliding_local_dilated__dense_activation_relu__prompt_kernel
.amdhsa_next_free_vgpr 256
.amdhsa_next_free_sgpr 102
.amdhsa_accum_offset 256
.amdhsa_group_segment_fixed_size 0
.amdhsa_kernarg_size 80
.amdhsa_user_sgpr_count 2
.amdhsa_user_sgpr_kernarg_segment_ptr 1
.amdhsa_system_sgpr_workgroup_id_x 1
.end_amdhsa_kernel
```
